```python
import torch

def _softmax(x, axis=-1):
    return torch.softmax(x, dim=axis)
def _gelu(x):
    return torch.nn.functional.gelu(x, approximate="tanh")
def _silu(x):
    return torch.nn.functional.silu(x)
def _sigmoid(x):
    return torch.sigmoid(x)
def _layernorm(x, axis=-1, eps=1e-5):
    m = x.mean(dim=axis, keepdim=True)
    v = x.var(dim=axis, keepdim=True, unbiased=False)
    return (x - m) / torch.sqrt(v + eps)
def _scatter_add(tgt, idx, src, axis=0):
    return tgt.clone().index_add_(axis, idx, src)
def _segment_sum(src, seg, n):
    out = torch.zeros((n,) + src.shape[1:], dtype=src.dtype)
    return out.index_add_(0, seg, src)
def _pad(x, pw):
    flat = tuple(v for pair in reversed(pw) for v in pair)
    return torch.nn.functional.pad(x, flat)

kernel_name = 'parallel_sum__compressed_kv_cla__dense_activation_squared_relu__decode'

def setup_inputs():

    _w = (lambda a: (lambda t: t.to(torch.bfloat16) if t.is_floating_point() else t)(torch.as_tensor(a)))
    def _A_setup():
        B, H, Sq, Sk, D, M = 2, 32, 1, 4096, 192, 640
        Dc = 4 * D
        return {
            "x": _w((lambda *s: torch.randn(*s, dtype=torch.bfloat16) * 0.05)(B, Sq, M)),
            "c_kv": _w((lambda *s: torch.randn(*s, dtype=torch.bfloat16) * 3.2)(B, Sk, Dc)),
            "w_q": _w((lambda *s: torch.randn(*s, dtype=torch.bfloat16) * 1.6)(M, H, D) * (M ** -0.5)),
            "w_uk": _w((lambda *s: torch.randn(*s, dtype=torch.bfloat16) * 1.6)(Dc, H, D) * (Dc ** -0.5)),
            "w_uv": _w((lambda *s: torch.randn(*s, dtype=torch.bfloat16) * 3.2)(Dc, H, D) * (Dc ** -0.5)),
            "w_o": _w((lambda *s: torch.randn(*s, dtype=torch.bfloat16) * 3.2)(H, D, M) * ((H * D) ** -0.5)),
        }
    _A_in = _A_setup()

    def _B_setup():
        B, S, D, F = 2, 1, 640, 1536
        return {
            "x": _w((lambda *s: torch.randn(*s, dtype=torch.bfloat16) * 0.05)(B, S, D)),
            "w1": _w((lambda *s: torch.randn(*s, dtype=torch.bfloat16) * 0.1)(D, F)),
            "b1": _w((lambda *s: torch.randn(*s, dtype=torch.bfloat16) * 0.8)(F)),
            "w2": _w((lambda *s: torch.randn(*s, dtype=torch.bfloat16) * 0.1)(F, D)),
            "b2": _w((lambda *s: torch.randn(*s, dtype=torch.bfloat16) * 12.8)(D)),
        }
    _B_in = _B_setup()

    return {
        "A_x": _A_in["x"],
        "A_c_kv": _A_in["c_kv"],
        "A_w_q": _A_in["w_q"],
        "A_w_uk": _A_in["w_uk"],
        "A_w_uv": _A_in["w_uv"],
        "A_w_o": _A_in["w_o"],
        "B_x": _B_in["x"],
        "B_w1": _B_in["w1"],
        "B_b1": _B_in["b1"],
        "B_w2": _B_in["w2"],
        "B_b2": _B_in["b2"],
    }

def reference(A_x, A_c_kv, A_w_q, A_w_uk, A_w_uv, A_w_o, B_x, B_w1, B_b1, B_w2, B_b2):
    def _A_ref(x, c_kv, w_q, w_uk, w_uv, w_o):
        B, Sq, M = x.shape[0], x.shape[1], x.shape[2]
        Sk = c_kv.shape[1]
        H, D = w_q.shape[1], w_q.shape[2]
        q = torch.einsum("bqm,mhd->bhqd", x, w_q)
        k = torch.einsum("bkc,chd->bhkd", c_kv, w_uk)
        v = torch.einsum("bkc,chd->bhkd", c_kv, w_uv)
        scores = torch.einsum("bhqd,bhkd->bhqk", q, k) * (D ** -0.5)
        off = Sk - Sq
        qi = torch.arange(Sq)[:, None]
        kj = torch.arange(Sk)[None, :]
        cmask = kj <= (qi + off)
        scores = torch.where(cmask[None, None], scores, -1e9)
        p = _softmax(scores, axis=-1)
        ctx = torch.einsum("bhqk,bhkd->bhqd", p, v)
        return torch.einsum("bhqd,hdm->bqm", ctx, w_o)

    def _B_ref(x, w1, b1, w2, b2):
        h = torch.einsum("bsd,df->bsf", x, w1) + b1
        zero = torch.zeros_like(h)
        r = torch.where(h > zero, h, zero)
        h = r * r
        out = torch.einsum("bsf,fd->bsd", h, w2) + b2
        return out

    x = A_x
    xn = _layernorm(x, axis=-1)
    return x + _A_ref(xn, A_c_kv, A_w_q, A_w_uk, A_w_uv, A_w_o) + _B_ref(xn, B_w1, B_b1, B_w2, B_b2)
```

```asm
; @launch grid=(256,1,1) block=(512,1,1) lds=157440
.amdgcn_target "amdgcn-amd-amdhsa--gfx950"
.text
.globl parallel_sum__compressed_kv_cla__dense_activation_squared_relu__decode_kernel
.p2align 8
.type parallel_sum__compressed_kv_cla__dense_activation_squared_relu__decode_kernel,@function
parallel_sum__compressed_kv_cla__dense_activation_squared_relu__decode_kernel:
    s_cmp_ge_u32 s2, 256
    s_cbranch_scc1 L_end
    s_load_dwordx16 s[8:23], s[0:1], 0
    s_load_dwordx8 s[24:31], s[0:1], 64
    s_load_dwordx4 s[32:35], s[0:1], 96
    v_and_b32 v1, 63, v0
    v_lshrrev_b32 v2, 6, v0
    v_and_b32 v4, 15, v1
    v_readfirstlane_b32 s3, v2
    v_lshrrev_b32 v5, 4, v1
    s_cmp_lg_u32 s3, 6
    s_cbranch_scc1 L_nopf
    s_cmp_ge_u32 s2, 16
    s_cbranch_scc1 L_nopf
    s_getpc_b64 s[60:61]
L_pcbase:
    v_lshlrev_b32 v3, 7, v1
    v_cmp_gt_u32 vcc, L_codeend-L_pcbase, v3
    s_and_saveexec_b64 s[98:99], vcc
    s_cbranch_execz L_pf0
    global_load_dword v255, v3, s[60:61]
L_pf0:
    s_mov_b64 exec, s[98:99]
    v_add_u32 v3, 8192, v3
    v_cmp_gt_u32 vcc, L_codeend-L_pcbase, v3
    s_and_saveexec_b64 s[98:99], vcc
    s_cbranch_execz L_pf1
    global_load_dword v255, v3, s[60:61]
L_pf1:
    s_mov_b64 exec, s[98:99]
    v_add_u32 v3, 8192, v3
L_nopf:
    s_lshr_b32 s4, s2, 3
    s_and_b32 s5, s2, 7
    s_lshr_b32 s64, s2, 2
    s_and_b32 s65, s2, 3
    s_cmp_ge_u32 s64, 48
    s_cselect_b32 s71, 1, 0
    s_mov_b32 s66, 12288
    s_cselect_b32 s66, 3072, s66
    s_cselect_b32 s67, 48, 0
    s_sub_u32 s67, s64, s67
    s_lshl_b32 s67, s67, 8
    s_mul_i32 s68, s65, 160
    s_lshl_b32 s69, s3, 5
    s_add_u32 s68, s68, s69
    s_mul_i32 s68, s68, s66
    s_add_u32 s68, s68, s67
    s_lshl_b32 s69, s66, 2
    v_mul_lo_u32 v3, v5, s66
    v_lshl_add_u32 v3, v4, 4, v3
    v_mul_u32_u24 v2, 20, v1
    s_mul_i32 s70, s3, 1280
    v_mov_b32 v7, 0
    s_waitcnt lgkmcnt(0)
    s_mov_b32 s36, s34
    s_and_b32 s37, s35, 0xffff
    s_mov_b32 s38, 268435456
    s_mov_b32 s39, 0x00020000
    s_mov_b32 s48, s8
    s_and_b32 s49, s9, 0xffff
    s_mov_b32 s50, 2560
    s_mov_b32 s51, 0x00020000
    s_mov_b32 s44, s30
    s_and_b32 s45, s31, 0xffff
    s_mov_b32 s46, 2560
    s_mov_b32 s47, 0x00020000
    s_cmp_ge_u32 s3, 2
    s_cbranch_scc1 L_nox
    buffer_load_dwordx4 v[8:11], v2, s[48:51], s70 offen
    buffer_load_dword v12, v2, s[48:51], s70 offen offset:16
    buffer_load_dword v26, v7, s[36:39], 0 offen sc1
L_nox:
    s_cmp_ge_u32 s2, 240
    s_cbranch_scc1 L_s1_noload
    s_cmp_ge_u32 s3, 5
    s_cbranch_scc1 L_s1_noload
    s_cmp_eq_u32 s71, 1
    s_cselect_b32 s40, s22, s12
    s_cselect_b32 s41, s23, s13
    s_mov_b32 s42, 7864320
    s_cselect_b32 s42, 1966080, s42
    s_and_b32 s41, s41, 0xffff
    s_mov_b32 s43, 0x00020000
    buffer_load_dwordx4 v[64:67], v3, s[40:43], s68 offen nt
    s_add_u32 s68, s68, s69
    buffer_load_dwordx4 v[68:71], v3, s[40:43], s68 offen nt
    s_add_u32 s68, s68, s69
    buffer_load_dwordx4 v[72:75], v3, s[40:43], s68 offen nt
    s_add_u32 s68, s68, s69
    buffer_load_dwordx4 v[76:79], v3, s[40:43], s68 offen nt
    s_add_u32 s68, s68, s69
    buffer_load_dwordx4 v[80:83], v3, s[40:43], s68 offen nt
    s_add_u32 s68, s68, s69
    buffer_load_dwordx4 v[84:87], v3, s[40:43], s68 offen nt
    s_add_u32 s68, s68, s69
    buffer_load_dwordx4 v[88:91], v3, s[40:43], s68 offen nt
    s_add_u32 s68, s68, s69
    buffer_load_dwordx4 v[92:95], v3, s[40:43], s68 offen nt
L_s1_noload:
    v_and_b32 v6, 1, v1
    v_cmp_eq_u32 vcc, 1, v6
    v_mov_b32 v6, 0xffff
    v_mov_b32 v7, 0xffff0000
    v_cndmask_b32 v6, v6, v7, vcc
    v_bfe_u32 v7, v1, 1, 2
    v_cmp_eq_u32 vcc, 0, v7
    s_nop 1
    v_cndmask_b32 v28, 0, v6, vcc
    v_cmp_eq_u32 vcc, 1, v7
    s_nop 1
    v_cndmask_b32 v29, 0, v6, vcc
    v_cmp_eq_u32 vcc, 2, v7
    s_nop 1
    v_cndmask_b32 v30, 0, v6, vcc
    v_cmp_eq_u32 vcc, 3, v7
    s_nop 1
    v_cndmask_b32 v31, 0, v6, vcc
    v_mov_b32 v27, 0xffffff00
    s_mov_b32 s57, 0x0c0c0400
    s_mov_b32 s58, 0x04000c0c
    s_cmp_lg_u32 s3, 2
    s_cbranch_scc1 L_nozero
    v_lshlrev_b32 v6, 2, v1
    v_add_u32 v6, 156800, v6
    v_mov_b32 v7, 0
    v_cmp_gt_u32 vcc, 16, v1
    s_and_saveexec_b64 s[98:99], vcc
    v_cmp_ne_u32 vcc, 8, v1
    s_and_b64 exec, exec, vcc
    ds_write_b32 v6, v7
    s_mov_b64 exec, s[98:99]
L_nozero:
    s_cmp_ge_u32 s3, 2
    s_cbranch_scc1 L_ln_done
    s_cmp_lt_u32 s2, 240
    s_cbranch_scc1 L_ln_w
    s_waitcnt vmcnt(0)
L_ln_w:
    s_waitcnt vmcnt(8)
    v_mov_b32 v6, 156832
    ds_write_b32 v6, v26
    v_lshlrev_b32 v32, 16, v8
    v_and_b32 v33, 0xffff0000, v8
    v_lshlrev_b32 v34, 16, v9
    v_and_b32 v35, 0xffff0000, v9
    v_lshlrev_b32 v36, 16, v10
    v_and_b32 v37, 0xffff0000, v10
    v_lshlrev_b32 v38, 16, v11
    v_and_b32 v39, 0xffff0000, v11
    v_lshlrev_b32 v40, 16, v12
    v_and_b32 v41, 0xffff0000, v12
    v_add_f32 v6, v32, v33
    v_add_f32 v7, v34, v35
    v_add_f32 v6, v6, v36
    v_add_f32 v7, v7, v37
    v_add_f32 v6, v6, v38
    v_add_f32 v7, v7, v39
    v_add_f32 v6, v6, v40
    v_add_f32 v7, v7, v41
    v_add_f32 v6, v6, v7
    s_nop 1
    v_add_f32_dpp v6, v6, v6 row_ror:8 row_mask:0xf bank_mask:0xf
    s_nop 1
    v_add_f32_dpp v6, v6, v6 row_ror:4 row_mask:0xf bank_mask:0xf
    s_nop 1
    v_add_f32_dpp v6, v6, v6 row_ror:2 row_mask:0xf bank_mask:0xf
    s_nop 1
    v_add_f32_dpp v6, v6, v6 row_ror:1 row_mask:0xf bank_mask:0xf
    v_mov_b32 v7, v6
    s_nop 1
    v_permlane16_swap_b32 v6, v7
    s_nop 1
    v_add_f32 v6, v6, v7
    v_mov_b32 v7, v6
    s_nop 1
    v_permlane32_swap_b32 v6, v7
    s_nop 1
    v_add_f32 v6, v6, v7
    v_mul_f32 v6, 0x3acccccd, v6
    v_sub_f32 v32, v32, v6
    v_sub_f32 v33, v33, v6
    v_sub_f32 v34, v34, v6
    v_sub_f32 v35, v35, v6
    v_sub_f32 v36, v36, v6
    v_sub_f32 v37, v37, v6
    v_sub_f32 v38, v38, v6
    v_sub_f32 v39, v39, v6
    v_sub_f32 v40, v40, v6
    v_sub_f32 v41, v41, v6
    v_mul_f32 v7, v32, v32
    v_mul_f32 v18, v33, v33
    v_fmac_f32 v7, v34, v34
    v_fmac_f32 v18, v35, v35
    v_fmac_f32 v7, v36, v36
    v_fmac_f32 v18, v37, v37
    v_fmac_f32 v7, v38, v38
    v_fmac_f32 v18, v39, v39
    v_fmac_f32 v7, v40, v40
    v_fmac_f32 v18, v41, v41
    v_add_f32 v7, v7, v18
    s_nop 1
    v_add_f32_dpp v7, v7, v7 row_ror:8 row_mask:0xf bank_mask:0xf
    s_nop 1
    v_add_f32_dpp v7, v7, v7 row_ror:4 row_mask:0xf bank_mask:0xf
    s_nop 1
    v_add_f32_dpp v7, v7, v7 row_ror:2 row_mask:0xf bank_mask:0xf
    s_nop 1
    v_add_f32_dpp v7, v7, v7 row_ror:1 row_mask:0xf bank_mask:0xf
    v_mov_b32 v18, v7
    s_nop 1
    v_permlane16_swap_b32 v7, v18
    s_nop 1
    v_add_f32 v7, v7, v18
    v_mov_b32 v18, v7
    s_nop 1
    v_permlane32_swap_b32 v7, v18
    s_nop 1
    v_add_f32 v7, v7, v18
    v_mov_b32 v18, 0x3727c5ac
    v_fmac_f32 v18, 0x3acccccd, v7
    v_rsq_f32 v7, v18
    s_and_b32 s64, s2, 3
    s_lshl_b32 s64, s64, 4
    v_subrev_u32 v6, s64, v1
    v_mul_f32 v32, v32, v7
    v_mul_f32 v33, v33, v7
    v_mul_f32 v34, v34, v7
    v_mul_f32 v35, v35, v7
    v_mul_f32 v36, v36, v7
    v_mul_f32 v37, v37, v7
    v_mul_f32 v38, v38, v7
    v_mul_f32 v39, v39, v7
    v_mul_f32 v40, v40, v7
    v_mul_f32 v41, v41, v7
    v_cvt_pk_bf16_f32 v32, v32, v32
    v_cvt_pk_bf16_f32 v33, v33, v33
    v_cvt_pk_bf16_f32 v34, v34, v34
    v_cvt_pk_bf16_f32 v35, v35, v35
    v_cvt_pk_bf16_f32 v36, v36, v36
    v_cvt_pk_bf16_f32 v37, v37, v37
    v_cvt_pk_bf16_f32 v38, v38, v38
    v_cvt_pk_bf16_f32 v39, v39, v39
    v_cvt_pk_bf16_f32 v40, v40, v40
    v_cvt_pk_bf16_f32 v41, v41, v41
    v_mul_u32_u24 v7, 40, v6
    s_mul_i32 s64, s3, 640
    s_add_u32 s64, s64, 155136
    v_add_u32 v7, s64, v7
    v_cmp_gt_u32 vcc, 16, v6
    s_and_saveexec_b64 s[98:99], vcc
    ds_write_b64 v7, v[32:33] offset:0
    ds_write_b64 v7, v[34:35] offset:8
    ds_write_b64 v7, v[36:37] offset:16
    ds_write_b64 v7, v[38:39] offset:24
    ds_write_b64 v7, v[40:41] offset:32
    s_mov_b64 exec, s[98:99]
L_ln_done:
    s_waitcnt lgkmcnt(0)
    s_barrier
    s_cmp_lt_u32 s3, 6
    s_cbranch_scc1 L_s2_noload
    s_mov_b32 s44, s14
    s_and_b32 s45, s15, 0xffff
    s_mov_b32 s46, 9437184
    s_mov_b32 s47, 0x00020000
    v_and_b32 v3, 7, v4
    v_mul_u32_u24 v3, 12288, v3
    v_lshrrev_b32 v2, 3, v4
    v_lshl_add_u32 v3, v2, 6, v3
    v_lshl_add_u32 v3, v5, 4, v3
    s_mul_i32 s64, s5, 96
    s_sub_u32 s65, s3, 6
    s_mul_i32 s65, s65, 48
    s_add_u32 s64, s64, s65
    s_mul_i32 s64, s64, 12288
    s_mul_i32 s65, s4, 384
    s_add_u32 s64, s64, s65
    buffer_load_dwordx4 v[84:87], v3, s[44:47], s64 offen offset:0 nt
    buffer_load_dwordx4 v[88:91], v3, s[44:47], s64 offen offset:128 nt
    buffer_load_dwordx4 v[92:95], v3, s[44:47], s64 offen offset:256 nt
    s_add_u32 s64, s64, 98304
    buffer_load_dwordx4 v[96:99], v3, s[44:47], s64 offen offset:0 nt
    buffer_load_dwordx4 v[100:103], v3, s[44:47], s64 offen offset:128 nt
    buffer_load_dwordx4 v[104:107], v3, s[44:47], s64 offen offset:256 nt
    s_add_u32 s64, s64, 98304
    buffer_load_dwordx4 v[108:111], v3, s[44:47], s64 offen offset:0 nt
    buffer_load_dwordx4 v[112:115], v3, s[44:47], s64 offen offset:128 nt
    buffer_load_dwordx4 v[116:119], v3, s[44:47], s64 offen offset:256 nt
    s_add_u32 s64, s64, 98304
    buffer_load_dwordx4 v[120:123], v3, s[44:47], s64 offen offset:0 nt
    buffer_load_dwordx4 v[124:127], v3, s[44:47], s64 offen offset:128 nt
    buffer_load_dwordx4 v[128:131], v3, s[44:47], s64 offen offset:256 nt
    s_add_u32 s64, s64, 98304
    buffer_load_dwordx4 v[132:135], v3, s[44:47], s64 offen offset:0 nt
    buffer_load_dwordx4 v[136:139], v3, s[44:47], s64 offen offset:128 nt
    buffer_load_dwordx4 v[140:143], v3, s[44:47], s64 offen offset:256 nt
    s_add_u32 s64, s64, 98304
    buffer_load_dwordx4 v[144:147], v3, s[44:47], s64 offen offset:0 nt
    buffer_load_dwordx4 v[148:151], v3, s[44:47], s64 offen offset:128 nt
    buffer_load_dwordx4 v[152:155], v3, s[44:47], s64 offen offset:256 nt
L_s2_noload:
    v_mov_b32 v6, 156832
    ds_read_b32 v26, v6
    v_bfe_u32 v6, v1, 3, 1
    v_mul_u32_u24 v6, 640, v6
    v_lshl_add_u32 v6, v5, 2, v6
    s_lshl_b32 s64, s3, 7
    s_add_u32 s64, s64, 155136
    v_add_u32 v6, s64, v6
    ds_read_b32 v16, v6 offset:0
    ds_read_b32 v17, v6 offset:16
    ds_read_b32 v18, v6 offset:32
    ds_read_b32 v19, v6 offset:48
    ds_read_b32 v20, v6 offset:64
    ds_read_b32 v21, v6 offset:80
    ds_read_b32 v22, v6 offset:96
    ds_read_b32 v23, v6 offset:112
    s_waitcnt lgkmcnt(8)
    v_readfirstlane_b32 s52, v26
    s_nop 3
    s_mul_i32 s52, s52, 0x9E3779B1
    s_add_u32 s52, s52, 0x7F4A7C15
    s_or_b32 s52, s52, 1
    s_bfe_u32 s53, s52, 0x80000
    s_bfe_u32 s54, s52, 0x80008
    s_bfe_u32 s55, s52, 0x80010
    s_bfe_u32 s56, s52, 0x80018
    s_cmp_ge_u32 s2, 240
    s_cbranch_scc1 L_s1_done
    s_cmp_ge_u32 s3, 5
    s_cbranch_scc1 L_s1_done
    s_waitcnt lgkmcnt(0)
    v_and_b32 v32, v16, v28
    v_and_b32 v33, v16, v29
    v_and_b32 v34, v16, v30
    v_and_b32 v35, v16, v31
    v_and_b32 v36, v17, v28
    v_and_b32 v37, v17, v29
    v_and_b32 v38, v17, v30
    v_and_b32 v39, v17, v31
    v_and_b32 v40, v18, v28
    v_and_b32 v41, v18, v29
    v_and_b32 v42, v18, v30
    v_and_b32 v43, v18, v31
    v_and_b32 v44, v19, v28
    v_and_b32 v45, v19, v29
    v_and_b32 v46, v19, v30
    v_and_b32 v47, v19, v31
    v_and_b32 v48, v20, v28
    v_and_b32 v49, v20, v29
    v_and_b32 v50, v20, v30
    v_and_b32 v51, v20, v31
    v_and_b32 v52, v21, v28
    v_and_b32 v53, v21, v29
    v_and_b32 v54, v21, v30
    v_and_b32 v55, v21, v31
    v_and_b32 v56, v22, v28
    v_and_b32 v57, v22, v29
    v_and_b32 v58, v22, v30
    v_and_b32 v59, v22, v31
    v_and_b32 v60, v23, v28
    v_and_b32 v61, v23, v29
    v_and_b32 v62, v23, v30
    v_and_b32 v63, v23, v31
    s_waitcnt vmcnt(7)
    v_mfma_f32_16x16x32_bf16 v[8:11], v[32:35], v[64:67], 0
    s_waitcnt vmcnt(6)
    v_mfma_f32_16x16x32_bf16 v[8:11], v[36:39], v[68:71], v[8:11]
    s_waitcnt vmcnt(5)
    v_mfma_f32_16x16x32_bf16 v[8:11], v[40:43], v[72:75], v[8:11]
    s_waitcnt vmcnt(4)
    v_mfma_f32_16x16x32_bf16 v[8:11], v[44:47], v[76:79], v[8:11]
    s_waitcnt vmcnt(3)
    v_mfma_f32_16x16x32_bf16 v[8:11], v[48:51], v[80:83], v[8:11]
    s_waitcnt vmcnt(2)
    v_mfma_f32_16x16x32_bf16 v[8:11], v[52:55], v[84:87], v[8:11]
    s_waitcnt vmcnt(1)
    v_mfma_f32_16x16x32_bf16 v[8:11], v[56:59], v[88:91], v[8:11]
    s_waitcnt vmcnt(0)
    v_mfma_f32_16x16x32_bf16 v[8:11], v[60:63], v[92:95], v[8:11]
    v_lshlrev_b32 v3, 4, v0
    v_add_u32 v3, 129024, v3
    s_nop 6
    ds_write_b128 v3, v[8:11]
L_s1_done:
    s_waitcnt lgkmcnt(0)
    s_barrier
    s_cmp_lg_u32 s3, 0
    s_cbranch_scc1 L_x1p_done
    s_cmp_ge_u32 s2, 240
    s_cbranch_scc1 L_x1p_done
    v_lshlrev_b32 v3, 4, v1
    v_add_u32 v3, 129024, v3
    ds_read_b128 v[32:35], v3 offset:0
    ds_read_b128 v[36:39], v3 offset:1024
    ds_read_b128 v[40:43], v3 offset:2048
    ds_read_b128 v[44:47], v3 offset:3072
    ds_read_b128 v[48:51], v3 offset:4096
    v_lshrrev_b32 v6, 5, v1
    v_mul_u32_u24 v6, 30720, v6
    v_lshl_add_u32 v6, v4, 5, v6
    v_bfe_u32 v7, v1, 4, 1
    v_lshl_add_u32 v6, v7, 4, v6
    s_lshr_b32 s64, s2, 2
    s_and_b32 s65, s2, 3
    s_mul_i32 s64, s64, 512
    s_mul_i32 s65, s65, 61440
    s_add_u32 s64, s64, s65
    s_add_u32 s64, s64, 65536
    s_lshr_b32 s70, s2, 2
    s_mul_i32 s71, s70, 43
    s_lshr_b32 s71, s71, 7
    s_mul_i32 s72, s71, 3
    s_sub_u32 s72, s70, s72
    s_lshl_b32 s71, s71, 1
    s_add_u32 s71, s71, s72
    v_and_b32 v12, 7, v1
    v_lshrrev_b32 v13, 3, v1
    v_sub_u32 v14, s71, v13
    v_lshl_add_u32 v12, v14, 3, v12
    v_lshlrev_b32 v12, 7, v12
    v_lshl_add_u32 v12, v13, 4, v12
    s_and_b32 s74, s2, 3
    s_lshl_b32 s74, s74, 2
    s_add_u32 s74, s74, 10485760
    s_mov_b32 s75, 0xff
    s_cmp_eq_u32 s72, 2
    s_cselect_b32 s75, 0, s75
    s_mov_b32 s73, 0xff00
    s_cmp_eq_u32 s72, 0
    s_cselect_b32 s73, 0, s73
    s_or_b32 s72, s75, s73
    s_cmp_ge_u32 s70, 48
    s_cselect_b32 s72, 0, s72
    s_mov_b32 s73, 0
    s_waitcnt lgkmcnt(3)
    v_add_f32 v32, v32, v36
    v_add_f32 v33, v33, v37
    v_add_f32 v34, v34, v38
    v_add_f32 v35, v35, v39
    s_waitcnt lgkmcnt(2)
    v_add_f32 v32, v32, v40
    v_add_f32 v33, v33, v41
    v_add_f32 v34, v34, v42
    v_add_f32 v35, v35, v43
    s_waitcnt lgkmcnt(1)
    v_add_f32 v32, v32, v44
    v_add_f32 v33, v33, v45
    v_add_f32 v34, v34, v46
    v_add_f32 v35, v35, v47
    s_waitcnt lgkmcnt(0)
    v_add_f32 v32, v32, v48
    v_add_f32 v33, v33, v49
    v_add_f32 v34, v34, v50
    v_add_f32 v35, v35, v51
    v_and_or_b32 v32, v32, v27, s53
    v_and_or_b32 v33, v33, v27, s54
    v_and_or_b32 v34, v34, v27, s55
    v_and_or_b32 v35, v35, v27, s56
    buffer_store_dwordx4 v[32:35], v6, s[36:39], s64 offen sc1
    s_cmp_eq_u64 s[72:73], 0
    s_cbranch_scc1 L_x1p_done
    v_mov_b32 v7, s52
    s_mov_b64 s[98:99], exec
    s_mov_b64 exec, s[72:73]
    buffer_store_dword v7, v12, s[36:39], s74 offen sc1
    s_mov_b64 exec, s[98:99]
L_x1p_done:
    s_barrier
    s_cmp_lt_u32 s3, 6
    s_cbranch_scc1 L_att_ids
    v_lshlrev_b32 v3, 4, v1
    s_mul_i32 s65, s4, 768
    s_add_u32 s33, s65, 65536
    s_lshl_b32 s64, s2, 7
    s_add_u32 s97, s64, 10485760
    s_sub_u32 s32, s3, 6
    s_mul_i32 s64, s32, 768
    s_add_u32 s64, s64, 153600
    v_lshlrev_b32 v14, 3, v1
    v_add_u32 v14, s64, v14
    v_and_b32 v15, 1, v1
    v_mul_u32_u24 v15, 384, v15
    v_lshl_add_u32 v15, v5, 4, v15
    v_bfe_u32 v16, v1, 1, 1
    v_lshl_add_u32 v15, v16, 6, v15
    v_add_u32 v15, s64, v15
    s_mul_i32 s64, s32, 192
    s_add_u32 s64, s64, 156928
    v_mul_u32_u24 v16, 96, v4
    v_lshl_add_u32 v16, v5, 3, v16
    v_add_u32 v16, s64, v16
    v_lshrrev_b32 v17, 3, v1
    v_mul_u32_u24 v18, 96, v17
    v_and_b32 v19, 7, v1
    v_mad_u32_u24 v18, v19, 12, v18
    v_add_u32 v18, s64, v18
    v_lshlrev_b32 v17, 16, v17
    v_lshl_add_u32 v17, v19, 4, v17
    s_add_u32 s62, s34, s97
    s_addc_u32 s63, s35, 0
    s_mov_b32 s60, s52
    s_mov_b32 s61, s52
    s_mov_b32 s96, 0
L_pollx1_1:
    s_add_u32 s96, s96, 1
    s_cmp_ge_u32 s96, 524288
    s_cbranch_scc1 L_pdonex1_2
    s_load_dwordx8 s[64:71], s[62:63], 0 glc
    s_waitcnt lgkmcnt(0)
    s_cmp_eq_u64 s[64:65], s[60:61]
    s_cbranch_scc0 L_pollx1_1
    s_cmp_eq_u64 s[66:67], s[60:61]
    s_cbranch_scc0 L_pollx1_1
    s_cmp_eq_u64 s[68:69], s[60:61]
    s_cbranch_scc0 L_pollx1_1
    s_cmp_eq_u64 s[70:71], s[60:61]
    s_cbranch_scc0 L_pollx1_1
L_pdonex1_2:
    v_cmp_gt_u32 vcc, 48, v1
    s_and_saveexec_b64 s[98:99], vcc
    s_add_u32 s64, s33, 0
    buffer_load_dwordx4 v[32:35], v3, s[36:39], s64 offen sc1
    s_add_u32 s64, s64, 61440
    buffer_load_dwordx4 v[36:39], v3, s[36:39], s64 offen sc1
    s_add_u32 s64, s64, 61440
    buffer_load_dwordx4 v[40:43], v3, s[36:39], s64 offen sc1
    s_add_u32 s64, s64, 61440
    buffer_load_dwordx4 v[44:47], v3, s[36:39], s64 offen sc1
    s_add_u32 s64, s33, 30720
    buffer_load_dwordx4 v[48:51], v3, s[36:39], s64 offen sc1
    s_add_u32 s64, s64, 61440
    buffer_load_dwordx4 v[52:55], v3, s[36:39], s64 offen sc1
    s_add_u32 s64, s64, 61440
    buffer_load_dwordx4 v[56:59], v3, s[36:39], s64 offen sc1
    s_add_u32 s64, s64, 61440
    buffer_load_dwordx4 v[60:63], v3, s[36:39], s64 offen sc1
    s_lshl_b32 s64, s3, 2
    s_add_u32 s64, s64, 156816
    v_mov_b32 v6, s64
    v_mov_b32 v7, s52
    ds_write_b32 v6, v7
    s_mov_b32 s70, 0
L_x1_chk:
    s_waitcnt vmcnt(0)
L_x1_chk1:
    s_mov_b64 s[64:65], 0
    v_perm_b32 v6, v33, v32, s57
    v_perm_b32 v7, v35, v34, s58
    v_or_b32 v6, v6, v7
    v_cmp_ne_u32 vcc, s52, v6
    s_or_b64 s[64:65], s[64:65], vcc
    v_perm_b32 v6, v37, v36, s57
    v_perm_b32 v7, v39, v38, s58
    v_or_b32 v6, v6, v7
    v_cmp_ne_u32 vcc, s52, v6
    s_or_b64 s[64:65], s[64:65], vcc
    v_perm_b32 v6, v41, v40, s57
    v_perm_b32 v7, v43, v42, s58
    v_or_b32 v6, v6, v7
    v_cmp_ne_u32 vcc, s52, v6
    s_or_b64 s[64:65], s[64:65], vcc
    v_perm_b32 v6, v45, v44, s57
    v_perm_b32 v7, v47, v46, s58
    v_or_b32 v6, v6, v7
    v_cmp_ne_u32 vcc, s52, v6
    s_or_b64 s[64:65], s[64:65], vcc
    v_perm_b32 v6, v49, v48, s57
    v_perm_b32 v7, v51, v50, s58
    v_or_b32 v6, v6, v7
    v_cmp_ne_u32 vcc, s52, v6
    s_or_b64 s[64:65], s[64:65], vcc
    v_perm_b32 v6, v53, v52, s57
    v_perm_b32 v7, v55, v54, s58
    v_or_b32 v6, v6, v7
    v_cmp_ne_u32 vcc, s52, v6
    s_or_b64 s[64:65], s[64:65], vcc
    v_perm_b32 v6, v57, v56, s57
    v_perm_b32 v7, v59, v58, s58
    v_or_b32 v6, v6, v7
    v_cmp_ne_u32 vcc, s52, v6
    s_or_b64 s[64:65], s[64:65], vcc
    v_perm_b32 v6, v61, v60, s57
    v_perm_b32 v7, v63, v62, s58
    v_or_b32 v6, v6, v7
    v_cmp_ne_u32 vcc, s52, v6
    s_or_b64 s[64:65], s[64:65], vcc
    s_cmp_eq_u64 s[64:65], 0
    s_cbranch_scc0 L_x1_retry
L_x1_ok:
    v_add_f32 v32, v32, v36
    v_add_f32 v40, v40, v44
    v_add_f32 v33, v33, v37
    v_add_f32 v41, v41, v45
    v_add_f32 v34, v34, v38
    v_add_f32 v42, v42, v46
    v_add_f32 v35, v35, v39
    v_add_f32 v43, v43, v47
    v_add_f32 v32, v32, v40
    v_add_f32 v33, v33, v41
    v_add_f32 v34, v34, v42
    v_add_f32 v35, v35, v43
    v_cvt_pk_bf16_f32 v32, v32, v33
    v_cvt_pk_bf16_f32 v33, v34, v35
    ds_write_b64 v14, v[32:33] offset:0
    v_add_f32 v48, v48, v52
    v_add_f32 v56, v56, v60
    v_add_f32 v49, v49, v53
    v_add_f32 v57, v57, v61
    v_add_f32 v50, v50, v54
    v_add_f32 v58, v58, v62
    v_add_f32 v51, v51, v55
    v_add_f32 v59, v59, v63
    v_add_f32 v48, v48, v56
    v_add_f32 v49, v49, v57
    v_add_f32 v50, v50, v58
    v_add_f32 v51, v51, v59
    v_cvt_pk_bf16_f32 v48, v48, v49
    v_cvt_pk_bf16_f32 v49, v50, v51
    ds_write_b64 v14, v[48:49] offset:384
    s_mov_b64 exec, s[98:99]
    s_waitcnt lgkmcnt(0)
    ds_read_b128 v[8:11], v15 offset:0
    ds_read_b128 v[56:59], v15 offset:128
    ds_read_b128 v[20:23], v15 offset:256
    s_waitcnt lgkmcnt(2)
    v_mfma_f32_16x16x32_bf16 v[32:35], v[84:87], v[8:11], 0
    v_mfma_f32_16x16x32_bf16 v[36:39], v[96:99], v[8:11], 0
    v_mfma_f32_16x16x32_bf16 v[40:43], v[108:111], v[8:11], 0
    v_mfma_f32_16x16x32_bf16 v[44:47], v[120:123], v[8:11], 0
    v_mfma_f32_16x16x32_bf16 v[48:51], v[132:135], v[8:11], 0
    v_mfma_f32_16x16x32_bf16 v[52:55], v[144:147], v[8:11], 0
    s_waitcnt lgkmcnt(1)
    v_mfma_f32_16x16x32_bf16 v[32:35], v[88:91], v[56:59], v[32:35]
    v_mfma_f32_16x16x32_bf16 v[36:39], v[100:103], v[56:59], v[36:39]
    v_mfma_f32_16x16x32_bf16 v[40:43], v[112:115], v[56:59], v[40:43]
    v_mfma_f32_16x16x32_bf16 v[44:47], v[124:127], v[56:59], v[44:47]
    v_mfma_f32_16x16x32_bf16 v[48:51], v[136:139], v[56:59], v[48:51]
    v_mfma_f32_16x16x32_bf16 v[52:55], v[148:151], v[56:59], v[52:55]
    s_waitcnt lgkmcnt(0)
    v_mfma_f32_16x16x32_bf16 v[32:35], v[92:95], v[20:23], v[32:35]
    v_mfma_f32_16x16x32_bf16 v[36:39], v[104:107], v[20:23], v[36:39]
    v_mfma_f32_16x16x32_bf16 v[40:43], v[116:119], v[20:23], v[40:43]
    v_mfma_f32_16x16x32_bf16 v[44:47], v[128:131], v[20:23], v[44:47]
    v_mfma_f32_16x16x32_bf16 v[48:51], v[140:143], v[20:23], v[48:51]
    v_mfma_f32_16x16x32_bf16 v[52:55], v[152:155], v[20:23], v[52:55]
    s_nop 7
    v_permlane32_swap_b32 v32, v36
    v_permlane32_swap_b32 v33, v37
    v_permlane32_swap_b32 v34, v38
    v_permlane32_swap_b32 v35, v39
    v_permlane32_swap_b32 v40, v44
    v_permlane32_swap_b32 v41, v45
    v_permlane32_swap_b32 v42, v46
    v_permlane32_swap_b32 v43, v47
    v_permlane32_swap_b32 v48, v52
    v_permlane32_swap_b32 v49, v53
    v_permlane32_swap_b32 v50, v54
    v_permlane32_swap_b32 v51, v55
    s_nop 1
    v_add_f32_dpp v32, v36, v32 row_shl:2 row_mask:0xf bank_mask:0xf
    v_add_f32_dpp v33, v37, v33 row_shl:2 row_mask:0xf bank_mask:0xf
    v_add_f32_dpp v34, v38, v34 row_shl:2 row_mask:0xf bank_mask:0xf
    v_add_f32_dpp v35, v39, v35 row_shl:2 row_mask:0xf bank_mask:0xf
    v_add_f32_dpp v40, v44, v40 row_shl:2 row_mask:0xf bank_mask:0xf
    v_add_f32_dpp v41, v45, v41 row_shl:2 row_mask:0xf bank_mask:0xf
    v_add_f32_dpp v42, v46, v42 row_shl:2 row_mask:0xf bank_mask:0xf
    v_add_f32_dpp v43, v47, v43 row_shl:2 row_mask:0xf bank_mask:0xf
    v_add_f32_dpp v48, v52, v48 row_shl:2 row_mask:0xf bank_mask:0xf
    v_add_f32_dpp v49, v53, v49 row_shl:2 row_mask:0xf bank_mask:0xf
    v_add_f32_dpp v50, v54, v50 row_shl:2 row_mask:0xf bank_mask:0xf
    v_add_f32_dpp v51, v55, v51 row_shl:2 row_mask:0xf bank_mask:0xf
    v_cmp_gt_u32 vcc, 2, v4
    s_lshl_b32 s65, s4, 11
    s_lshl_b32 s66, s5, 8
    s_add_u32 s65, s65, s66
    s_lshl_b32 s66, s32, 7
    s_add_u32 s65, s65, s66
    s_add_u32 s65, s65, 327680
    v_cvt_pk_bf16_f32 v32, v32, v33
    v_cvt_pk_bf16_f32 v33, v34, v35
    v_cvt_pk_bf16_f32 v40, v40, v41
    v_cvt_pk_bf16_f32 v41, v42, v43
    v_cvt_pk_bf16_f32 v48, v48, v49
    v_cvt_pk_bf16_f32 v49, v50, v51
    s_and_saveexec_b64 s[98:99], vcc
    ds_write_b64 v16, v[32:33] offset:0
    ds_write_b64 v16, v[40:41] offset:32
    ds_write_b64 v16, v[48:49] offset:64
    s_mov_b64 exec, s[98:99]
    s_waitcnt lgkmcnt(0)
    v_cmp_gt_u32 vcc, 16, v1
    s_and_saveexec_b64 s[98:99], vcc
    ds_read_b32 v32, v18
    ds_read_b32 v33, v18 offset:4
    ds_read_b32 v34, v18 offset:8
    v_mov_b32 v35, s52
    s_waitcnt lgkmcnt(0)
    buffer_store_dwordx4 v[32:35], v17, s[36:39], s65 offen sc1
    s_mov_b64 exec, s[98:99]
L_att_ids:
    s_and_b32 s64, s2, 7
    s_lshr_b32 s65, s2, 4
    s_lshl_b32 s65, s65, 3
    s_add_u32 s64, s64, s65
    s_bfe_u32 s59, s2, 0x10003
    s_lshr_b32 s6, s64, 6
    s_and_b32 s7, s64, 63
    v_lshrrev_b32 v6, 2, v4
    v_and_b32 v7, 3, v4
    v_and_b32 v8, 1, v5
    v_lshl_add_u32 v6, v8, 2, v6
    v_lshrrev_b32 v8, 1, v5
    v_lshl_add_u32 v6, v8, 4, v6
    v_mul_u32_u24 v6, 1568, v6
    v_mul_u32_u24 v8, 48, v7
    v_add_u32 v6, v6, v8
    s_mul_i32 s65, s3, 192
    s_add_u32 s65, s65, 28672
    v_add_u32 v24, s65, v6
    v_add_u32 v7, 1, v7
    v_bfe_u32 v7, v7, 1, 1
    v_lshlrev_b32 v7, 3, v7
    v_add_u32 v25, v24, v7
    v_sub_u32 v24, v24, v7
    s_lshl_b32 s65, s3, 4
    v_add_u32 v22, s65, v4
    v_mul_u32_u24 v22, 1568, v22
    v_lshl_add_u32 v22, v5, 4, v22
    v_add_u32 v22, 28672, v22
    v_mul_u32_u24 v23, 1568, v4
    v_lshl_add_u32 v23, v5, 4, v23
    v_add_u32 v23, 3072, v23
    s_cmp_ge_u32 s3, 6
    s_cbranch_scc1 L_ck_wait
    s_mov_b32 s40, s10
    s_and_b32 s41, s11, 0xffff
    s_mov_b32 s42, 12582912
    s_mov_b32 s43, 0x00020000
    s_mul_i32 s66, s64, 98304
    s_min_u32 s65, s3, 2
    s_lshl_b32 s67, s3, 4
    s_add_u32 s65, s65, s67
    s_lshl_b32 s67, s65, 6
    v_add_u32 v6, s67, v1
    s_lshl_b32 s67, s65, 10
    s_add_u32 s67, s67, 28672
    s_cmp_lt_u32 s3, 2
    s_cselect_b32 s69, 17, 16
    s_mov_b32 s68, 0
L_dma_loop:
    v_mul_u32_u24 v7, 42800, v6
    v_lshrrev_b32 v7, 22, v7
    v_mul_u32_u24 v8, 98, v7
    v_sub_u32 v8, v6, v8
    v_min_u32 v8, 95, v8
    v_mul_u32_u24 v7, 1536, v7
    v_lshl_add_u32 v7, v8, 4, v7
    s_mov_b32 m0, s67
    v_add_u32 v6, 64, v6
    buffer_load_dwordx4 v7, s[40:43], s66 offen nt lds
    s_add_u32 s67, s67, 1024
    s_add_u32 s68, s68, 1
    s_cmp_lg_u32 s68, 6
    s_cbranch_scc1 L_dma_noph
    v_mov_b32 v12, v6
    v_mov_b32 v6, 156800
    s_mov_b32 s96, 0
L_lwxg_3:
    s_add_u32 s96, s96, 1
    s_cmp_ge_u32 s96, 2097152
    s_cbranch_scc1 L_lwdxg_4
    ds_read_b64 v[8:9], v6 offset:40
    s_waitcnt lgkmcnt(0)
    v_cmp_ne_u32 vcc, s52, v8
    v_cmp_ne_u32 s[60:61], s52, v9
    s_or_b64 vcc, vcc, s[60:61]
    s_cmp_eq_u64 vcc, 0
    s_cbranch_scc0 L_lwxg_3
L_lwdxg_4:
    v_mov_b32 v6, v12
L_dma_noph:
    s_cmp_lt_u32 s68, s69
    s_cbranch_scc1 L_dma_loop
    s_waitcnt vmcnt(0)
    s_lshl_b32 s64, s3, 2
    s_add_u32 s64, s64, 156800
    v_mov_b32 v6, s64
    v_mov_b32 v7, s52
    ds_write_b32 v6, v7
L_ck_wait:
    v_mov_b32 v6, 156800
    s_mov_b32 s96, 0
L_lwck_5:
    s_add_u32 s96, s96, 1
    s_cmp_ge_u32 s96, 2097152
    s_cbranch_scc1 L_lwdck_6
    ds_read_b128 v[8:11], v6
    ds_read_b64 v[12:13], v6 offset:16
    s_waitcnt lgkmcnt(0)
    v_cmp_ne_u32 vcc, s52, v8
    v_cmp_ne_u32 s[60:61], s52, v9
    s_or_b64 vcc, vcc, s[60:61]
    v_cmp_ne_u32 s[60:61], s52, v10
    s_or_b64 vcc, vcc, s[60:61]
    v_cmp_ne_u32 s[60:61], s52, v11
    s_or_b64 vcc, vcc, s[60:61]
    v_cmp_ne_u32 s[60:61], s52, v12
    s_or_b64 vcc, vcc, s[60:61]
    v_cmp_ne_u32 s[60:61], s52, v13
    s_or_b64 vcc, vcc, s[60:61]
    s_cmp_eq_u64 vcc, 0
    s_cbranch_scc0 L_lwck_5
L_lwdck_6:
    s_cmp_ge_u32 s3, 4
    s_cbranch_scc1 L_qg
    ds_read_b128 v[64:67], v22 offset:0
    ds_read_b128 v[68:71], v22 offset:64
    ds_read_b128 v[72:75], v22 offset:128
    ds_read_b128 v[76:79], v22 offset:192
    ds_read_b128 v[80:83], v22 offset:256
    ds_read_b128 v[84:87], v22 offset:320
    ds_read_b128 v[88:91], v22 offset:384
    ds_read_b128 v[92:95], v22 offset:448
    ds_read_b128 v[96:99], v22 offset:512
    ds_read_b128 v[100:103], v22 offset:576
    ds_read_b128 v[104:107], v22 offset:640
    ds_read_b128 v[108:111], v22 offset:704
    ds_read_b128 v[112:115], v22 offset:768
    ds_read_b128 v[116:119], v22 offset:832
    ds_read_b128 v[120:123], v22 offset:896
    ds_read_b128 v[124:127], v22 offset:960
    ds_read_b128 v[128:131], v22 offset:1024
    ds_read_b128 v[132:135], v22 offset:1088
    ds_read_b128 v[136:139], v22 offset:1152
    ds_read_b128 v[140:143], v22 offset:1216
    ds_read_b128 v[144:147], v22 offset:1280
    ds_read_b128 v[148:151], v22 offset:1344
    ds_read_b128 v[152:155], v22 offset:1408
    ds_read_b128 v[156:159], v22 offset:1472
    ds_read_b64_tr_b16 v[160:161], v25 offset:0
    ds_read_b64_tr_b16 v[162:163], v25 offset:12544
    ds_read_b64_tr_b16 v[164:165], v25 offset:50176
    ds_read_b64_tr_b16 v[166:167], v25 offset:62720
    ds_read_b64_tr_b16 v[168:169], v24 offset:8
    ds_read_b64_tr_b16 v[170:171], v24 offset:12552
    ds_read_b64_tr_b16 v[172:173], v24 offset:50184
    ds_read_b64_tr_b16 v[174:175], v24 offset:62728
    ds_read_b64_tr_b16 v[176:177], v25 offset:16
    ds_read_b64_tr_b16 v[178:179], v25 offset:12560
    ds_read_b64_tr_b16 v[180:181], v25 offset:50192
    ds_read_b64_tr_b16 v[182:183], v25 offset:62736
    ds_read_b64_tr_b16 v[184:185], v24 offset:24
    ds_read_b64_tr_b16 v[186:187], v24 offset:12568
    ds_read_b64_tr_b16 v[188:189], v24 offset:50200
    ds_read_b64_tr_b16 v[190:191], v24 offset:62744
    ds_read_b64_tr_b16 v[192:193], v25 offset:32
    ds_read_b64_tr_b16 v[194:195], v25 offset:12576
    ds_read_b64_tr_b16 v[196:197], v25 offset:50208
    ds_read_b64_tr_b16 v[198:199], v25 offset:62752
    ds_read_b64_tr_b16 v[200:201], v24 offset:40
    ds_read_b64_tr_b16 v[202:203], v24 offset:12584
    ds_read_b64_tr_b16 v[204:205], v24 offset:50216
    ds_read_b64_tr_b16 v[206:207], v24 offset:62760
    s_waitcnt lgkmcnt(0)
    s_branch L_preB4
L_qg:
    s_sub_u32 s65, s3, 4
    s_lshl_b32 s66, s6, 16
    s_lshl_b32 s64, s59, 15
    s_add_u32 s66, s66, s64
    s_lshl_b32 s64, s65, 13
    s_add_u32 s66, s66, s64
    s_add_u32 s32, s66, 327680
    v_lshlrev_b32 v2, 4, v1
    v_add_u32 v3, 4096, v2
    buffer_load_dwordx4 v[32:35], v2, s[36:39], s32 offen offset:0 sc1
    buffer_load_dwordx4 v[36:39], v2, s[36:39], s32 offen offset:1024 sc1
    buffer_load_dwordx4 v[40:43], v2, s[36:39], s32 offen offset:2048 sc1
    buffer_load_dwordx4 v[44:47], v2, s[36:39], s32 offen offset:3072 sc1
    buffer_load_dwordx4 v[48:51], v3, s[36:39], s32 offen offset:0 sc1
    buffer_load_dwordx4 v[52:55], v3, s[36:39], s32 offen offset:1024 sc1
    buffer_load_dwordx4 v[56:59], v3, s[36:39], s32 offen offset:2048 sc1
    buffer_load_dwordx4 v[60:63], v3, s[36:39], s32 offen offset:3072 sc1
    v_mul_u32_u24 v9, 12, v1
    s_mul_i32 s64, s65, 6272
    s_add_u32 s64, s64, 3072
    v_add_u32 v9, s64, v9
    ds_read_b64_tr_b16 v[160:161], v25 offset:0
    ds_read_b64_tr_b16 v[162:163], v25 offset:12544
    ds_read_b64_tr_b16 v[164:165], v25 offset:50176
    ds_read_b64_tr_b16 v[166:167], v25 offset:62720
    ds_read_b64_tr_b16 v[168:169], v24 offset:8
    ds_read_b64_tr_b16 v[170:171], v24 offset:12552
    ds_read_b64_tr_b16 v[172:173], v24 offset:50184
    ds_read_b64_tr_b16 v[174:175], v24 offset:62728
    ds_read_b64_tr_b16 v[176:177], v25 offset:16
    ds_read_b64_tr_b16 v[178:179], v25 offset:12560
    ds_read_b64_tr_b16 v[180:181], v25 offset:50192
    ds_read_b64_tr_b16 v[182:183], v25 offset:62736
    ds_read_b64_tr_b16 v[184:185], v24 offset:24
    ds_read_b64_tr_b16 v[186:187], v24 offset:12568
    ds_read_b64_tr_b16 v[188:189], v24 offset:50200
    ds_read_b64_tr_b16 v[190:191], v24 offset:62744
    ds_read_b64_tr_b16 v[192:193], v25 offset:32
    ds_read_b64_tr_b16 v[194:195], v25 offset:12576
    ds_read_b64_tr_b16 v[196:197], v25 offset:50208
    ds_read_b64_tr_b16 v[198:199], v25 offset:62752
    ds_read_b64_tr_b16 v[200:201], v24 offset:40
    ds_read_b64_tr_b16 v[202:203], v24 offset:12584
    ds_read_b64_tr_b16 v[204:205], v24 offset:50216
    ds_read_b64_tr_b16 v[206:207], v24 offset:62760
    s_waitcnt vmcnt(0)
    s_mov_b32 s70, 0
L_q_chk:
    s_mov_b64 s[66:67], 0
    v_cmp_ne_u32 s[72:73], s52, v35
    s_or_b64 s[66:67], s[66:67], s[72:73]
    v_cmp_ne_u32 s[74:75], s52, v39
    s_or_b64 s[66:67], s[66:67], s[74:75]
    v_cmp_ne_u32 s[76:77], s52, v43
    s_or_b64 s[66:67], s[66:67], s[76:77]
    v_cmp_ne_u32 s[78:79], s52, v47
    s_or_b64 s[66:67], s[66:67], s[78:79]
    v_cmp_ne_u32 s[80:81], s52, v51
    s_or_b64 s[66:67], s[66:67], s[80:81]
    v_cmp_ne_u32 s[82:83], s52, v55
    s_or_b64 s[66:67], s[66:67], s[82:83]
    v_cmp_ne_u32 s[84:85], s52, v59
    s_or_b64 s[66:67], s[66:67], s[84:85]
    v_cmp_ne_u32 s[86:87], s52, v63
    s_or_b64 s[66:67], s[66:67], s[86:87]
    s_cmp_eq_u64 s[66:67], 0
    s_cbranch_scc0 L_q_retry
L_q_ok:
    ds_write_b32 v9, v32 offset:0
    ds_write_b32 v9, v33 offset:4
    ds_write_b32 v9, v34 offset:8
    ds_write_b32 v9, v36 offset:768
    ds_write_b32 v9, v37 offset:772
    ds_write_b32 v9, v38 offset:776
    ds_write_b32 v9, v40 offset:1568
    ds_write_b32 v9, v41 offset:1572
    ds_write_b32 v9, v42 offset:1576
    ds_write_b32 v9, v44 offset:2336
    ds_write_b32 v9, v45 offset:2340
    ds_write_b32 v9, v46 offset:2344
    ds_write_b32 v9, v48 offset:3136
    ds_write_b32 v9, v49 offset:3140
    ds_write_b32 v9, v50 offset:3144
    ds_write_b32 v9, v52 offset:3904
    ds_write_b32 v9, v53 offset:3908
    ds_write_b32 v9, v54 offset:3912
    ds_write_b32 v9, v56 offset:4704
    ds_write_b32 v9, v57 offset:4708
    ds_write_b32 v9, v58 offset:4712
    ds_write_b32 v9, v60 offset:5472
    ds_write_b32 v9, v61 offset:5476
    ds_write_b32 v9, v62 offset:5480
    s_mov_b32 s44, s16
    s_and_b32 s45, s17, 0xffff
    s_mov_b32 s46, 9437184
    s_mov_b32 s47, 0x00020000
    v_mul_u32_u24 v26, 12288, v5
    v_lshl_add_u32 v26, v4, 4, v26
    s_mul_i32 s64, s5, 96
    s_mul_i32 s65, s3, 12
    s_add_u32 s64, s64, s65
    s_mul_i32 s64, s64, 12288
    s_mul_i32 s65, s4, 384
    s_add_u32 s64, s64, s65
    s_mov_b32 s66, s64
    buffer_load_dwordx4 v[228:231], v26, s[44:47], s64 offen nt
    s_add_u32 s64, s64, 49152
    buffer_load_dwordx4 v[232:235], v26, s[44:47], s64 offen nt
    s_add_u32 s64, s64, 49152
    buffer_load_dwordx4 v[236:239], v26, s[44:47], s64 offen nt
    v_cmp_gt_u32 vcc, 8, v4
    s_and_saveexec_b64 s[98:99], vcc
    buffer_load_dwordx4 v[240:243], v26, s[44:47], s66 offen offset:256 nt
    s_add_u32 s66, s66, 49152
    buffer_load_dwordx4 v[244:247], v26, s[44:47], s66 offen offset:256 nt
    s_add_u32 s66, s66, 49152
    buffer_load_dwordx4 v[248:251], v26, s[44:47], s66 offen offset:256 nt
    s_mov_b64 exec, s[98:99]
L_q_fin:
    s_waitcnt lgkmcnt(0)
L_preB4:
    s_barrier
    s_cmp_lt_u32 s3, 4
    s_cbranch_scc1 L_qk
    s_branch L_noqk
L_qk:
    ds_read_b128 v[208:211], v23 offset:0
    ds_read_b128 v[212:215], v23 offset:64
    ds_read_b128 v[216:219], v23 offset:128
    ds_read_b128 v[220:223], v23 offset:192
    ds_read_b128 v[224:227], v23 offset:256
    s_waitcnt lgkmcnt(4)
    v_mfma_f32_16x16x32_bf16 v[56:59], v[64:67], v[208:211], 0
    ds_read_b128 v[208:211], v23 offset:320
    s_waitcnt lgkmcnt(4)
    v_mfma_f32_16x16x32_bf16 v[56:59], v[68:71], v[212:215], v[56:59]
    ds_read_b128 v[212:215], v23 offset:384
    s_waitcnt lgkmcnt(4)
    v_mfma_f32_16x16x32_bf16 v[56:59], v[72:75], v[216:219], v[56:59]
    ds_read_b128 v[216:219], v23 offset:448
    s_waitcnt lgkmcnt(4)
    v_mfma_f32_16x16x32_bf16 v[56:59], v[76:79], v[220:223], v[56:59]
    ds_read_b128 v[220:223], v23 offset:512
    s_waitcnt lgkmcnt(4)
    v_mfma_f32_16x16x32_bf16 v[56:59], v[80:83], v[224:227], v[56:59]
    ds_read_b128 v[224:227], v23 offset:576
    s_waitcnt lgkmcnt(4)
    v_mfma_f32_16x16x32_bf16 v[56:59], v[84:87], v[208:211], v[56:59]
    ds_read_b128 v[208:211], v23 offset:640
    s_waitcnt lgkmcnt(4)
    v_mfma_f32_16x16x32_bf16 v[56:59], v[88:91], v[212:215], v[56:59]
    ds_read_b128 v[212:215], v23 offset:704
    s_waitcnt lgkmcnt(4)
    v_mfma_f32_16x16x32_bf16 v[56:59], v[92:95], v[216:219], v[56:59]
    ds_read_b128 v[216:219], v23 offset:768
    s_waitcnt lgkmcnt(4)
    v_mfma_f32_16x16x32_bf16 v[56:59], v[96:99], v[220:223], v[56:59]
    ds_read_b128 v[220:223], v23 offset:832
    s_waitcnt lgkmcnt(4)
    v_mfma_f32_16x16x32_bf16 v[56:59], v[100:103], v[224:227], v[56:59]
    ds_read_b128 v[224:227], v23 offset:896
    s_waitcnt lgkmcnt(4)
    v_mfma_f32_16x16x32_bf16 v[56:59], v[104:107], v[208:211], v[56:59]
    ds_read_b128 v[208:211], v23 offset:960
    s_waitcnt lgkmcnt(4)
    v_mfma_f32_16x16x32_bf16 v[56:59], v[108:111], v[212:215], v[56:59]
    ds_read_b128 v[212:215], v23 offset:1024
    s_waitcnt lgkmcnt(4)
    v_mfma_f32_16x16x32_bf16 v[56:59], v[112:115], v[216:219], v[56:59]
    ds_read_b128 v[216:219], v23 offset:1088
    s_waitcnt lgkmcnt(4)
    v_mfma_f32_16x16x32_bf16 v[56:59], v[116:119], v[220:223], v[56:59]
    ds_read_b128 v[220:223], v23 offset:1152
    s_waitcnt lgkmcnt(4)
    v_mfma_f32_16x16x32_bf16 v[56:59], v[120:123], v[224:227], v[56:59]
    ds_read_b128 v[224:227], v23 offset:1216
    s_waitcnt lgkmcnt(4)
    v_mfma_f32_16x16x32_bf16 v[56:59], v[124:127], v[208:211], v[56:59]
    ds_read_b128 v[208:211], v23 offset:1280
    s_waitcnt lgkmcnt(4)
    v_mfma_f32_16x16x32_bf16 v[56:59], v[128:131], v[212:215], v[56:59]
    ds_read_b128 v[212:215], v23 offset:1344
    s_waitcnt lgkmcnt(4)
    v_mfma_f32_16x16x32_bf16 v[56:59], v[132:135], v[216:219], v[56:59]
    ds_read_b128 v[216:219], v23 offset:1408
    s_waitcnt lgkmcnt(4)
    v_mfma_f32_16x16x32_bf16 v[56:59], v[136:139], v[220:223], v[56:59]
    ds_read_b128 v[220:223], v23 offset:1472
    s_waitcnt lgkmcnt(4)
    v_mfma_f32_16x16x32_bf16 v[56:59], v[140:143], v[224:227], v[56:59]
    s_waitcnt lgkmcnt(3)
    v_mfma_f32_16x16x32_bf16 v[56:59], v[144:147], v[208:211], v[56:59]
    s_waitcnt lgkmcnt(2)
    v_mfma_f32_16x16x32_bf16 v[56:59], v[148:151], v[212:215], v[56:59]
    s_waitcnt lgkmcnt(1)
    v_mfma_f32_16x16x32_bf16 v[56:59], v[152:155], v[216:219], v[56:59]
    s_waitcnt lgkmcnt(0)
    v_mfma_f32_16x16x32_bf16 v[56:59], v[156:159], v[220:223], v[56:59]
    s_mov_b32 s44, s16
    s_and_b32 s45, s17, 0xffff
    s_mov_b32 s46, 9437184
    s_mov_b32 s47, 0x00020000
    v_mul_u32_u24 v26, 12288, v5
    v_lshl_add_u32 v26, v4, 4, v26
    s_mul_i32 s64, s5, 96
    s_mul_i32 s65, s3, 12
    s_add_u32 s64, s64, s65
    s_mul_i32 s64, s64, 12288
    s_mul_i32 s65, s4, 384
    s_add_u32 s64, s64, s65
    s_mov_b32 s66, s64
    buffer_load_dwordx4 v[228:231], v26, s[44:47], s64 offen nt
    s_add_u32 s64, s64, 49152
    buffer_load_dwordx4 v[232:235], v26, s[44:47], s64 offen nt
    s_add_u32 s64, s64, 49152
    buffer_load_dwordx4 v[236:239], v26, s[44:47], s64 offen nt
    v_cmp_gt_u32 vcc, 8, v4
    s_and_saveexec_b64 s[98:99], vcc
    buffer_load_dwordx4 v[240:243], v26, s[44:47], s66 offen offset:256 nt
    s_add_u32 s66, s66, 49152
    buffer_load_dwordx4 v[244:247], v26, s[44:47], s66 offen offset:256 nt
    s_add_u32 s66, s66, 49152
    buffer_load_dwordx4 v[248:251], v26, s[44:47], s66 offen offset:256 nt
    s_mov_b64 exec, s[98:99]
    s_mov_b32 s64, 0x3dd53b95
    v_lshlrev_b32 v10, 4, v4
    s_lshl_b32 s65, s3, 2
    v_add_u32 v10, s65, v10
    s_nop 4
    v_mul_f32 v56, s64, v56
    v_mul_f32 v57, s64, v57
    v_mul_f32 v58, s64, v58
    v_mul_f32 v59, s64, v59
    v_max_f32 v60, v56, v57
    v_max3_f32 v60, v60, v58, v59
    v_mov_b32 v61, v60
    s_nop 1
    v_permlane16_swap_b32 v60, v61
    s_nop 1
    v_max_f32 v60, v60, v61
    v_mov_b32 v61, v60
    s_nop 1
    v_permlane32_swap_b32 v60, v61
    s_nop 1
    v_max_f32 v60, v60, v61
    ds_write_b32 v10, v60 offset:2304
    s_waitcnt lgkmcnt(0)
L_noqk:
    s_barrier
    v_lshlrev_b32 v11, 4, v4
    ds_read_b128 v[60:63], v11 offset:2304
    s_waitcnt lgkmcnt(0)
    v_max_f32 v60, v60, v61
    v_max3_f32 v60, v60, v62, v63
    s_cmp_ge_u32 s3, 4
    s_cbranch_scc1 L_nosm
    v_sub_f32 v56, v56, v60
    v_sub_f32 v57, v57, v60
    v_sub_f32 v58, v58, v60
    v_sub_f32 v59, v59, v60
    v_exp_f32 v56, v56
    v_exp_f32 v57, v57
    v_exp_f32 v58, v58
    v_exp_f32 v59, v59
    v_mul_u32_u24 v12, 144, v4
    v_lshl_add_u32 v12, v5, 3, v12
    s_lshl_b32 s64, s3, 5
    v_add_u32 v12, s64, v12
    v_cvt_pk_bf16_f32 v62, v56, v57
    v_cvt_pk_bf16_f32 v63, v58, v59
    ds_write_b64 v12, v[62:63] offset:0
    v_lshlrev_b32 v56, 16, v62
    v_and_b32 v57, 0xffff0000, v62
    v_lshlrev_b32 v58, 16, v63
    v_and_b32 v59, 0xffff0000, v63
    v_add_f32 v56, v56, v57
    v_add_f32 v58, v58, v59
    v_add_f32 v61, v56, v58
    v_mov_b32 v56, v61
    s_nop 1
    v_permlane16_swap_b32 v61, v56
    s_nop 1
    v_add_f32 v61, v61, v56
    v_mov_b32 v56, v61
    s_nop 1
    v_permlane32_swap_b32 v61, v56
    s_nop 1
    v_add_f32 v61, v61, v56
    ds_write_b32 v10, v61 offset:2560
    s_waitcnt lgkmcnt(0)
L_nosm:
    v_mul_u32_u24 v12, 144, v4
    v_and_b32 v8, 1, v5
    v_lshl_add_u32 v12, v8, 3, v12
    v_lshrrev_b32 v8, 1, v5
    v_lshl_add_u32 v12, v8, 5, v12
    v_and_b32 v2, 11, v4
    v_mul_u32_u24 v2, 262144, v2
    v_lshl_add_u32 v2, v5, 4, v2
    v_bfe_u32 v59, v4, 2, 1
    v_lshl_add_u32 v2, v59, 6, v2
    v_add_u32 v59, 1048576, v2
    s_lshl_b32 s64, s59, 22
    s_lshl_b32 s65, s3, 15
    s_add_u32 s64, s64, s65
    s_lshl_b32 s65, s6, 6
    s_add_u32 s65, s65, s7
    s_lshl_b32 s66, s65, 8
    s_add_u32 s64, s64, s66
    s_add_u32 s64, s64, 2097152
    s_cmp_lt_u32 s3, 4
    s_cbranch_scc1 L_nopvp
    s_setprio 1
L_nopvp:
    s_barrier
    ds_read2_b64 v[16:19], v12 offset0:0 offset1:2
    ds_read2_b64 v[20:23], v12 offset0:8 offset1:10
    ds_read_b128 v[8:11], v11 offset:2560
    s_waitcnt lgkmcnt(2)
    v_mfma_f32_16x16x32_bf16 v[32:35], v[160:163], v[16:19], 0
    v_mfma_f32_16x16x32_bf16 v[36:39], v[168:171], v[16:19], 0
    v_mfma_f32_16x16x32_bf16 v[40:43], v[176:179], v[16:19], 0
    v_mfma_f32_16x16x32_bf16 v[44:47], v[184:187], v[16:19], 0
    v_mfma_f32_16x16x32_bf16 v[48:51], v[192:195], v[16:19], 0
    v_mfma_f32_16x16x32_bf16 v[52:55], v[200:203], v[16:19], 0
    s_waitcnt lgkmcnt(1)
    v_mfma_f32_16x16x32_bf16 v[32:35], v[164:167], v[20:23], v[32:35]
    v_mfma_f32_16x16x32_bf16 v[36:39], v[172:175], v[20:23], v[36:39]
    v_mfma_f32_16x16x32_bf16 v[40:43], v[180:183], v[20:23], v[40:43]
    v_mfma_f32_16x16x32_bf16 v[44:47], v[188:191], v[20:23], v[44:47]
    v_mfma_f32_16x16x32_bf16 v[48:51], v[196:199], v[20:23], v[48:51]
    v_mfma_f32_16x16x32_bf16 v[52:55], v[204:207], v[20:23], v[52:55]
    s_waitcnt lgkmcnt(0)
    v_add_f32 v8, v8, v9
    v_add_f32 v10, v10, v11
    v_add_f32 v61, v8, v10
    v_rcp_f32 v9, v61
    v_mov_b32 v62, 0
    v_mov_b32 v63, s52
    s_nop 1
    v_cvt_pk_bf16_f32 v208, v32, v33
    v_cvt_pk_bf16_f32 v209, v34, v35
    v_cvt_pk_bf16_f32 v210, v36, v37
    v_mov_b32 v211, s52
    v_cvt_pk_bf16_f32 v212, v38, v39
    v_cvt_pk_bf16_f32 v213, v40, v41
    v_cvt_pk_bf16_f32 v214, v42, v43
    v_mov_b32 v215, s52
    v_mov_b32 v56, v212
    v_mov_b32 v57, v213
    v_mov_b32 v58, v214
    s_nop 0
    v_mov_b32_dpp v212, v208 row_shl:4 row_mask:0xf bank_mask:0x5
    v_mov_b32_dpp v213, v209 row_shl:4 row_mask:0xf bank_mask:0x5
    v_mov_b32_dpp v214, v210 row_shl:4 row_mask:0xf bank_mask:0x5
    v_mov_b32_dpp v208, v56 row_shr:4 row_mask:0xf bank_mask:0xa
    v_mov_b32_dpp v209, v57 row_shr:4 row_mask:0xf bank_mask:0xa
    v_mov_b32_dpp v210, v58 row_shr:4 row_mask:0xf bank_mask:0xa
    buffer_store_dwordx4 v[208:211], v2, s[36:39], s64 offen offset:0 sc1
    buffer_store_dwordx4 v[212:215], v59, s[36:39], s64 offen offset:0 sc1
    s_setprio 0
    v_cvt_pk_bf16_f32 v216, v44, v45
    v_cvt_pk_bf16_f32 v217, v46, v47
    v_cvt_pk_bf16_f32 v218, v48, v49
    v_mov_b32 v219, s52
    v_cvt_pk_bf16_f32 v220, v50, v51
    v_cvt_pk_bf16_f32 v221, v52, v53
    v_cvt_pk_bf16_f32 v222, v54, v55
    v_mov_b32 v223, s52
    v_mov_b32 v56, v220
    v_mov_b32 v57, v221
    v_mov_b32 v58, v222
    s_nop 0
    v_mov_b32_dpp v220, v216 row_shl:4 row_mask:0xf bank_mask:0x5
    v_mov_b32_dpp v221, v217 row_shl:4 row_mask:0xf bank_mask:0x5
    v_mov_b32_dpp v222, v218 row_shl:4 row_mask:0xf bank_mask:0x5
    v_mov_b32_dpp v216, v56 row_shr:4 row_mask:0xf bank_mask:0xa
    v_mov_b32_dpp v217, v57 row_shr:4 row_mask:0xf bank_mask:0xa
    v_mov_b32_dpp v218, v58 row_shr:4 row_mask:0xf bank_mask:0xa
    buffer_store_dwordx4 v[216:219], v2, s[36:39], s64 offen offset:128 sc1
    buffer_store_dwordx4 v[220:223], v59, s[36:39], s64 offen offset:128 sc1
    s_cmp_lg_u32 s3, 0
    s_cbranch_scc1 L_nost
    v_lshlrev_b32 v8, 4, v4
    s_lshl_b32 s64, s59, 15
    s_lshl_b32 s66, s65, 8
    s_add_u32 s64, s64, s66
    s_add_u32 s64, s64, 1179648
    s_mov_b64 s[98:99], exec
    s_mov_b64 exec, 0xffff
    buffer_store_dwordx4 v[60:63], v8, s[36:39], s64 offen sc1
    s_mov_b64 exec, s[98:99]
L_nost:
    v_lshlrev_b32 v6, 12, v4
    s_lshl_b32 s64, s59, 16
    s_lshl_b32 s66, s3, 9
    s_add_u32 s64, s64, s66
    s_lshl_b32 s66, s65, 2
    s_add_u32 s64, s64, s66
    s_add_u32 s64, s64, 10616832
    s_mov_b64 s[66:67], 0xffff
    v_mov_b32 v7, s52
    s_mov_b64 s[98:99], exec
    s_mov_b64 exec, s[66:67]
    buffer_store_dword v7, v6, s[36:39], s64 offen sc1
    s_mov_b64 exec, s[98:99]
    s_waitcnt vmcnt(0)
    s_lshl_b32 s64, s2, 9
    s_lshl_b32 s65, s3, 6
    s_add_u32 s64, s64, s65
    s_add_u32 s97, s64, 10616832
    v_lshlrev_b32 v3, 8, v5
    v_lshl_add_u32 v3, v4, 4, v3
    v_lshlrev_b32 v2, 8, v4
    v_bfe_u32 v10, v1, 3, 1
    s_mul_i32 s64, s3, 12
    v_add_u32 v11, s64, v5
    v_add_u32 v12, 0, v11
    v_mul_u32_u24 v13, 43, v12
    v_lshrrev_b32 v13, 10, v13
    v_mul_u32_u24 v14, 24, v13
    v_sub_u32 v14, v12, v14
    v_add_u32 v15, 1, v13
    v_bfe_u32 v15, v15, 1, 1
    v_lshlrev_b32 v15, 2, v15
    v_xor_b32 v14, v14, v15
    v_mul_u32_u24 v15, 43, v14
    v_lshrrev_b32 v15, 8, v15
    v_lshl_add_u32 v13, v15, 2, v13
    v_mul_u32_u24 v15, 6, v15
    v_sub_u32 v14, v14, v15
    v_lshrrev_b32 v15, 2, v14
    v_lshl_add_u32 v15, v10, 1, v15
    v_lshl_add_u32 v13, v15, 4, v13
    v_lshlrev_b32 v13, 4, v13
    v_and_b32 v14, 3, v14
    v_lshl_add_u32 v13, v14, 2, v13
    v_lshl_add_u32 v13, v10, 12, v13
    v_add_u32 v24, 129024, v13
    v_add_u32 v12, 4, v11
    v_mul_u32_u24 v13, 43, v12
    v_lshrrev_b32 v13, 10, v13
    v_mul_u32_u24 v14, 24, v13
    v_sub_u32 v14, v12, v14
    v_add_u32 v15, 1, v13
    v_bfe_u32 v15, v15, 1, 1
    v_lshlrev_b32 v15, 2, v15
    v_xor_b32 v14, v14, v15
    v_mul_u32_u24 v15, 43, v14
    v_lshrrev_b32 v15, 8, v15
    v_lshl_add_u32 v13, v15, 2, v13
    v_mul_u32_u24 v15, 6, v15
    v_sub_u32 v14, v14, v15
    v_lshrrev_b32 v15, 2, v14
    v_lshl_add_u32 v15, v10, 1, v15
    v_lshl_add_u32 v13, v15, 4, v13
    v_lshlrev_b32 v13, 4, v13
    v_and_b32 v14, 3, v14
    v_lshl_add_u32 v13, v14, 2, v13
    v_lshl_add_u32 v13, v10, 12, v13
    v_add_u32 v25, 129024, v13
    v_add_u32 v12, 8, v11
    v_mul_u32_u24 v13, 43, v12
    v_lshrrev_b32 v13, 10, v13
    v_mul_u32_u24 v14, 24, v13
    v_sub_u32 v14, v12, v14
    v_add_u32 v15, 1, v13
    v_bfe_u32 v15, v15, 1, 1
    v_lshlrev_b32 v15, 2, v15
    v_xor_b32 v14, v14, v15
    v_mul_u32_u24 v15, 43, v14
    v_lshrrev_b32 v15, 8, v15
    v_lshl_add_u32 v13, v15, 2, v13
    v_mul_u32_u24 v15, 6, v15
    v_sub_u32 v14, v14, v15
    v_lshrrev_b32 v15, 2, v14
    v_lshl_add_u32 v15, v10, 1, v15
    v_lshl_add_u32 v13, v15, 4, v13
    v_lshlrev_b32 v13, 4, v13
    v_and_b32 v14, 3, v14
    v_lshl_add_u32 v13, v14, 2, v13
    v_lshl_add_u32 v13, v10, 12, v13
    v_add_u32 v26, 129024, v13
    s_lshl_b32 s64, s2, 15
    s_lshl_b32 s65, s3, 12
    s_add_u32 s64, s64, s65
    s_add_u32 s32, s64, 2097152
    s_lshr_b32 s64, s4, 4
    s_lshl_b32 s64, s64, 15
    s_lshl_b32 s65, s3, 12
    s_add_u32 s64, s64, s65
    s_and_b32 s65, s4, 15
    s_lshl_b32 s65, s65, 4
    s_add_u32 s64, s64, s65
    s_add_u32 s33, s64, 1179648
    s_add_u32 s62, s34, s97
    s_addc_u32 s63, s35, 0
    s_mov_b32 s60, s52
    s_mov_b32 s61, s52
    s_mov_b32 s96, 0
L_pollx3_7:
    s_add_u32 s96, s96, 1
    s_cmp_ge_u32 s96, 524288
    s_cbranch_scc1 L_pdonex3_8
    s_load_dwordx16 s[64:79], s[62:63], 0 glc
    s_waitcnt lgkmcnt(0)
    s_cmp_eq_u64 s[64:65], s[60:61]
    s_cbranch_scc0 L_pollx3_7
    s_cmp_eq_u64 s[66:67], s[60:61]
    s_cbranch_scc0 L_pollx3_7
    s_cmp_eq_u64 s[68:69], s[60:61]
    s_cbranch_scc0 L_pollx3_7
    s_cmp_eq_u64 s[70:71], s[60:61]
    s_cbranch_scc0 L_pollx3_7
    s_cmp_eq_u64 s[72:73], s[60:61]
    s_cbranch_scc0 L_pollx3_7
    s_cmp_eq_u64 s[74:75], s[60:61]
    s_cbranch_scc0 L_pollx3_7
    s_cmp_eq_u64 s[76:77], s[60:61]
    s_cbranch_scc0 L_pollx3_7
    s_cmp_eq_u64 s[78:79], s[60:61]
    s_cbranch_scc0 L_pollx3_7
L_pdonex3_8:
    s_mov_b64 exec, 0xffff
    buffer_load_dwordx4 v[8:11], v2, s[36:39], s33 offen sc1
    s_mov_b64 exec, -1
    buffer_load_dwordx4 v[32:35], v3, s[36:39], s32 offen offset:0 sc1
    buffer_load_dwordx4 v[36:39], v3, s[36:39], s32 offen offset:1024 sc1
    buffer_load_dwordx4 v[40:43], v3, s[36:39], s32 offen offset:2048 sc1
    buffer_load_dwordx4 v[44:47], v3, s[36:39], s32 offen offset:3072 sc1
    s_waitcnt vmcnt(0)
    s_mov_b32 s70, 0
L_x3_chk:
    v_cmp_ne_u32 vcc, s52, v11
    s_and_b64 s[64:65], vcc, 0xffff
    v_cmp_ne_u32 vcc, s52, v35
    s_or_b64 s[64:65], s[64:65], vcc
    v_cmp_ne_u32 vcc, s52, v39
    s_or_b64 s[64:65], s[64:65], vcc
    v_cmp_ne_u32 vcc, s52, v43
    s_or_b64 s[64:65], s[64:65], vcc
    v_cmp_ne_u32 vcc, s52, v47
    s_or_b64 s[64:65], s[64:65], vcc
    s_cmp_eq_u64 s[64:65], 0
    s_cbranch_scc0 L_x3_retry
L_x3_ok:
    v_mov_b32 v35, 0
    v_mov_b32 v39, 0
    v_mov_b32 v43, 0
    v_mov_b32 v47, 0
    v_mov_b32 v12, v8
    s_nop 1
    v_max_f32_dpp v12, v12, v12 row_ror:8 row_mask:0xf bank_mask:0xf
    s_nop 1
    v_max_f32_dpp v12, v12, v12 row_ror:4 row_mask:0xf bank_mask:0xf
    s_nop 1
    v_max_f32_dpp v12, v12, v12 row_ror:2 row_mask:0xf bank_mask:0xf
    s_nop 1
    v_max_f32_dpp v12, v12, v12 row_ror:1 row_mask:0xf bank_mask:0xf
    v_sub_f32 v8, v8, v12
    v_exp_f32 v8, v8
    v_lshlrev_b32 v15, 2, v5
    v_cvt_pk_bf16_f32 v8, v8, v8
    v_add_u32 v14, 0, v15
    ds_bpermute_b32 v16, v14, v8
    v_add_u32 v14, 16, v15
    ds_bpermute_b32 v17, v14, v8
    v_add_u32 v14, 32, v15
    ds_bpermute_b32 v18, v14, v8
    v_add_u32 v14, 48, v15
    ds_bpermute_b32 v19, v14, v8
    v_and_b32 v13, 0xffff0000, v8
    v_mul_f32 v13, v13, v9
    s_nop 1
    v_add_f32_dpp v13, v13, v13 row_ror:8 row_mask:0xf bank_mask:0xf
    s_nop 1
    v_add_f32_dpp v13, v13, v13 row_ror:4 row_mask:0xf bank_mask:0xf
    s_nop 1
    v_add_f32_dpp v13, v13, v13 row_ror:2 row_mask:0xf bank_mask:0xf
    s_nop 1
    v_add_f32_dpp v13, v13, v13 row_ror:1 row_mask:0xf bank_mask:0xf
    s_lshl_b32 s64, s3, 3
    s_add_u32 s64, s64, 156672
    v_mov_b32 v14, s64
    s_mov_b64 exec, 1
    ds_write_b64 v14, v[12:13]
    s_mov_b64 exec, -1
    v_bfe_u32 v10, v1, 3, 1
    s_lshr_b32 s64, s3, 2
    v_cmp_eq_u32 vcc, s64, v10
    s_waitcnt lgkmcnt(1)
    s_nop 0
    v_cndmask_b32 v16, 0, v16, vcc
    v_cndmask_b32 v17, 0, v17, vcc
    v_cndmask_b32 v18, 0, v18, vcc
    v_cndmask_b32 v19, 0, v19, vcc
    v_and_b32 v208, v16, v28
    v_and_b32 v209, v16, v29
    v_and_b32 v210, v16, v30
    v_and_b32 v211, v16, v31
    v_and_b32 v212, v17, v28
    v_and_b32 v213, v17, v29
    v_and_b32 v214, v17, v30
    v_and_b32 v215, v17, v31
    v_and_b32 v216, v18, v28
    v_and_b32 v217, v18, v29
    v_and_b32 v218, v18, v30
    v_and_b32 v219, v18, v31
    v_and_b32 v220, v19, v28
    v_and_b32 v221, v19, v29
    v_and_b32 v222, v19, v30
    v_and_b32 v223, v19, v31
    v_lshlrev_b32 v3, 4, v0
    v_add_u32 v3, 129024, v3
    v_mfma_f32_16x16x32_bf16 v[56:59], v[208:211], v[32:35], 0
    v_mfma_f32_16x16x32_bf16 v[56:59], v[212:215], v[36:39], v[56:59]
    v_mfma_f32_16x16x32_bf16 v[56:59], v[216:219], v[40:43], v[56:59]
    v_mfma_f32_16x16x32_bf16 v[56:59], v[220:223], v[44:47], v[56:59]
    v_lshlrev_b32 v10, 5, v10
    v_add_u32 v10, 156672, v10
    s_nop 5
    ds_write_b128 v3, v[56:59]
    s_waitcnt lgkmcnt(0)
    s_barrier
    ds_read_b128 v[32:35], v10
    ds_read_b128 v[36:39], v10 offset:16
    ds_read_b32 v40, v24 offset:0
    ds_read_b32 v41, v24 offset:1024
    ds_read_b32 v42, v24 offset:2048
    ds_read_b32 v43, v24 offset:3072
    ds_read_b32 v44, v25 offset:0
    ds_read_b32 v45, v25 offset:1024
    ds_read_b32 v46, v25 offset:2048
    ds_read_b32 v47, v25 offset:3072
    ds_read_b32 v48, v26 offset:0
    ds_read_b32 v49, v26 offset:1024
    ds_read_b32 v50, v26 offset:2048
    ds_read_b32 v51, v26 offset:3072
    s_waitcnt lgkmcnt(12)
    v_max_f32 v12, v32, v34
    v_max3_f32 v12, v12, v36, v38
    v_sub_f32 v32, v32, v12
    v_sub_f32 v34, v34, v12
    v_sub_f32 v36, v36, v12
    v_sub_f32 v38, v38, v12
    v_exp_f32 v32, v32
    v_exp_f32 v34, v34
    v_exp_f32 v36, v36
    v_exp_f32 v38, v38
    s_nop 0
    v_mul_f32 v13, v32, v33
    v_fmac_f32 v13, v34, v35
    v_fmac_f32 v13, v36, v37
    v_fmac_f32 v13, v38, v39
    v_rcp_f32 v13, v13
    s_waitcnt lgkmcnt(0)
    v_mul_f32 v16, v40, v32
    v_fmac_f32 v16, v41, v34
    v_fmac_f32 v16, v42, v36
    v_fmac_f32 v16, v43, v38
    v_mul_f32 v16, v16, v13
    v_cvt_pk_bf16_f32 v16, v16, v16
    v_mul_f32 v17, v44, v32
    v_fmac_f32 v17, v45, v34
    v_fmac_f32 v17, v46, v36
    v_fmac_f32 v17, v47, v38
    v_mul_f32 v17, v17, v13
    v_cvt_pk_bf16_f32 v17, v17, v17
    v_mul_f32 v18, v48, v32
    v_fmac_f32 v18, v49, v34
    v_fmac_f32 v18, v50, v36
    v_fmac_f32 v18, v51, v38
    v_mul_f32 v18, v18, v13
    v_cvt_pk_bf16_f32 v18, v18, v18
    v_and_b32 v208, v16, v28
    v_and_b32 v209, v16, v29
    v_and_b32 v210, v16, v30
    v_and_b32 v211, v16, v31
    v_and_b32 v212, v17, v28
    v_and_b32 v213, v17, v29
    v_and_b32 v214, v17, v30
    v_and_b32 v215, v17, v31
    v_and_b32 v216, v18, v28
    v_and_b32 v217, v18, v29
    v_and_b32 v218, v18, v30
    v_and_b32 v219, v18, v31
    s_nop 1
    v_mfma_f32_16x16x32_bf16 v[56:59], v[208:211], v[228:231], 0
    v_mfma_f32_16x16x32_bf16 v[60:63], v[208:211], v[240:243], 0
    v_mfma_f32_16x16x32_bf16 v[56:59], v[212:215], v[232:235], v[56:59]
    v_mfma_f32_16x16x32_bf16 v[60:63], v[212:215], v[244:247], v[60:63]
    v_mfma_f32_16x16x32_bf16 v[56:59], v[216:219], v[236:239], v[56:59]
    v_mfma_f32_16x16x32_bf16 v[60:63], v[216:219], v[248:251], v[60:63]
    s_nop 7
    ds_write_b128 v3, v[56:59] offset:8192
    ds_write_b128 v3, v[60:63] offset:16384
    s_mul_i32 s64, s2, 52429
    s_lshr_b32 s100, s64, 18
    s_mul_i32 s64, s100, 5
    s_sub_u32 s101, s2, s64
    s_cmp_ge_u32 s2, 240
    s_cbranch_scc1 L_s5_noload
    s_mov_b32 s40, s18
    s_and_b32 s41, s19, 0xffff
    s_mov_b32 s42, 7864320
    s_mov_b32 s43, 0x00020000
    s_mov_b32 s44, s26
    s_and_b32 s45, s27, 0xffff
    s_mov_b32 s46, 1966080
    s_mov_b32 s47, 0x00020000
    v_mul_u32_u24 v21, 1280, v5
    v_lshl_add_u32 v21, v4, 4, v21
    s_lshl_b32 s64, s100, 7
    s_lshl_b32 s65, s3, 4
    s_add_u32 s64, s64, s65
    s_mul_i32 s64, s64, 1280
    s_lshl_b32 s65, s101, 8
    s_add_u32 s64, s64, s65
    buffer_load_dwordx4 v[88:91], v21, s[40:43], s64 offen nt
    s_add_u32 s64, s64, 5120
    buffer_load_dwordx4 v[92:95], v21, s[40:43], s64 offen nt
    s_add_u32 s64, s64, 5120
    buffer_load_dwordx4 v[96:99], v21, s[40:43], s64 offen nt
    s_add_u32 s64, s64, 5120
    buffer_load_dwordx4 v[100:103], v21, s[40:43], s64 offen nt
    s_lshl_b32 s64, s100, 5
    s_lshl_b32 s66, s3, 2
    s_add_u32 s64, s64, s66
    s_mul_i32 s64, s64, 1280
    s_add_u32 s64, s64, s65
    buffer_load_dwordx4 v[104:107], v21, s[44:47], s64 offen nt
L_s5_noload:
    s_waitcnt lgkmcnt(0)
    s_barrier
    s_cmp_ge_u32 s3, 2
    s_cbranch_scc1 L_x4p_done
    v_lshlrev_b32 v3, 4, v1
    s_lshl_b32 s64, s3, 13
    s_add_u32 s64, s64, 137216
    v_add_u32 v3, s64, v3
    ds_read_b128 v[32:35], v3 offset:0
    ds_read_b128 v[36:39], v3 offset:1024
    ds_read_b128 v[40:43], v3 offset:2048
    ds_read_b128 v[44:47], v3 offset:3072
    ds_read_b128 v[48:51], v3 offset:4096
    ds_read_b128 v[52:55], v3 offset:5120
    ds_read_b128 v[56:59], v3 offset:6144
    ds_read_b128 v[60:63], v3 offset:7168
    v_lshrrev_b32 v6, 5, v1
    v_mul_u32_u24 v6, 24576, v6
    v_lshl_add_u32 v6, v4, 5, v6
    v_bfe_u32 v7, v1, 4, 1
    v_lshl_add_u32 v6, v7, 4, v6
    s_mul_i32 s64, s5, 49152
    s_mul_i32 s65, s4, 768
    s_add_u32 s64, s64, s65
    s_lshl_b32 s65, s3, 9
    s_add_u32 s64, s64, s65
    s_add_u32 s64, s64, 458752
    s_cmp_eq_u32 s3, 0
    s_cselect_b32 s65, 16, 8
    s_lshr_b32 s70, s4, 1
    s_mul_i32 s70, s70, 3
    s_and_b32 s71, s4, 1
    s_add_u32 s72, s70, s71
    s_add_u32 s72, s72, s3
    s_lshl_b32 s73, s71, 3
    s_add_u32 s73, s73, s5
    s_lshl_b32 s74, s71, 1
    s_add_u32 s74, s74, s70
    s_xor_b32 s75, s73, 8
    s_cmp_eq_u32 s3, 0
    s_cselect_b32 s74, s74, s72
    s_cselect_b32 s75, s75, s73
    s_mul_i32 s72, s72, 640
    s_lshl_b32 s73, s73, 2
    s_add_u32 s72, s72, s73
    s_mul_i32 s74, s74, 640
    s_lshl_b32 s75, s75, 2
    s_add_u32 s74, s74, s75
    v_and_b32 v12, 7, v1
    v_lshlrev_b32 v12, 7, v12
    v_mov_b32 v13, s72
    v_mov_b32 v14, s74
    v_cmp_gt_u32 vcc, 8, v1
    s_nop 1
    v_cndmask_b32 v13, v14, v13, vcc
    v_add_u32 v12, v12, v13
    s_mov_b32 s74, 10551296
    s_mov_b64 s[72:73], 0x1f1f
    s_waitcnt lgkmcnt(6)
    v_add_f32 v32, v32, v36
    v_add_f32 v33, v33, v37
    v_add_f32 v34, v34, v38
    v_add_f32 v35, v35, v39
    s_waitcnt lgkmcnt(4)
    v_add_f32 v40, v40, v44
    v_add_f32 v41, v41, v45
    v_add_f32 v42, v42, v46
    v_add_f32 v43, v43, v47
    s_waitcnt lgkmcnt(2)
    v_add_f32 v48, v48, v52
    v_add_f32 v49, v49, v53
    v_add_f32 v50, v50, v54
    v_add_f32 v51, v51, v55
    s_waitcnt lgkmcnt(0)
    v_add_f32 v56, v56, v60
    v_add_f32 v57, v57, v61
    v_add_f32 v58, v58, v62
    v_add_f32 v59, v59, v63
    v_add_f32 v32, v32, v40
    v_add_f32 v48, v48, v56
    v_add_f32 v33, v33, v41
    v_add_f32 v49, v49, v57
    v_add_f32 v34, v34, v42
    v_add_f32 v50, v50, v58
    v_add_f32 v35, v35, v43
    v_add_f32 v51, v51, v59
    v_add_f32 v32, v32, v48
    v_add_f32 v33, v33, v49
    v_add_f32 v34, v34, v50
    v_add_f32 v35, v35, v51
    v_and_or_b32 v32, v32, v27, s53
    v_and_or_b32 v33, v33, v27, s54
    v_and_or_b32 v34, v34, v27, s55
    v_and_or_b32 v35, v35, v27, s56
    v_cmp_gt_u32 vcc, s65, v4
    s_and_saveexec_b64 s[98:99], vcc
    buffer_store_dwordx4 v[32:35], v6, s[36:39], s64 offen sc1
    s_mov_b64 exec, s[98:99]
    v_mov_b32 v7, s52
    s_mov_b64 s[98:99], exec
    s_mov_b64 exec, s[72:73]
    buffer_store_dword v7, v12, s[36:39], s74 offen sc1
    s_mov_b64 exec, s[98:99]
L_x4p_done:
    s_cmp_ge_u32 s2, 240
    s_cbranch_scc1 L_fin
    s_cmp_lg_u32 s3, 0
    s_cbranch_scc1 L5_n0
    s_lshl_b32 s64, s2, 7
    s_add_u32 s97, s64, 10551296
    v_lshrrev_b32 v6, 5, v1
    v_and_b32 v7, 31, v1
    v_mul_u32_u24 v2, 24576, v6
    v_lshl_add_u32 v2, v7, 4, v2
    s_lshl_b32 s64, s100, 9
    s_add_u32 s33, s64, 458752
    s_add_u32 s62, s34, s97
    s_addc_u32 s63, s35, 0
    s_mov_b32 s60, s52
    s_mov_b32 s61, s52
    s_mov_b32 s96, 0
L_pollx4_9:
    s_add_u32 s96, s96, 1
    s_cmp_ge_u32 s96, 524288
    s_cbranch_scc1 L_pdonex4_10
    s_load_dwordx16 s[64:79], s[62:63], 0 glc
    s_waitcnt lgkmcnt(0)
    s_cmp_eq_u64 s[64:65], s[60:61]
    s_cbranch_scc0 L_pollx4_9
    s_cmp_eq_u64 s[66:67], s[60:61]
    s_cbranch_scc0 L_pollx4_9
    s_cmp_eq_u64 s[68:69], s[60:61]
    s_cbranch_scc0 L_pollx4_9
    s_cmp_eq_u64 s[70:71], s[60:61]
    s_cbranch_scc0 L_pollx4_9
    s_cmp_eq_u64 s[72:73], s[60:61]
    s_cbranch_scc0 L_pollx4_9
    s_cmp_eq_u64 s[74:75], s[60:61]
    s_cbranch_scc0 L_pollx4_9
    s_cmp_eq_u64 s[76:77], s[60:61]
    s_cbranch_scc0 L_pollx4_9
    s_cmp_eq_u64 s[78:79], s[60:61]
    s_cbranch_scc0 L_pollx4_9
L_pdonex4_10:
    s_mov_b32 s70, 0
L_x4_ld:
    s_mov_b32 s64, s33
    buffer_load_dwordx4 v[32:35], v2, s[36:39], s64 offen sc1
    s_add_u32 s64, s64, 49152
    buffer_load_dwordx4 v[36:39], v2, s[36:39], s64 offen sc1
    s_add_u32 s64, s64, 49152
    buffer_load_dwordx4 v[40:43], v2, s[36:39], s64 offen sc1
    s_add_u32 s64, s64, 49152
    buffer_load_dwordx4 v[44:47], v2, s[36:39], s64 offen sc1
    s_add_u32 s64, s64, 49152
    buffer_load_dwordx4 v[48:51], v2, s[36:39], s64 offen sc1
    s_add_u32 s64, s64, 49152
    buffer_load_dwordx4 v[52:55], v2, s[36:39], s64 offen sc1
    s_add_u32 s64, s64, 49152
    buffer_load_dwordx4 v[56:59], v2, s[36:39], s64 offen sc1
    s_add_u32 s64, s64, 49152
    buffer_load_dwordx4 v[60:63], v2, s[36:39], s64 offen sc1
    s_waitcnt vmcnt(0)
    s_mov_b64 s[64:65], 0
    v_perm_b32 v8, v33, v32, s57
    v_perm_b32 v9, v35, v34, s58
    v_or_b32 v8, v8, v9
    v_cmp_ne_u32 vcc, s52, v8
    s_or_b64 s[64:65], s[64:65], vcc
    v_perm_b32 v8, v37, v36, s57
    v_perm_b32 v9, v39, v38, s58
    v_or_b32 v8, v8, v9
    v_cmp_ne_u32 vcc, s52, v8
    s_or_b64 s[64:65], s[64:65], vcc
    v_perm_b32 v8, v41, v40, s57
    v_perm_b32 v9, v43, v42, s58
    v_or_b32 v8, v8, v9
    v_cmp_ne_u32 vcc, s52, v8
    s_or_b64 s[64:65], s[64:65], vcc
    v_perm_b32 v8, v45, v44, s57
    v_perm_b32 v9, v47, v46, s58
    v_or_b32 v8, v8, v9
    v_cmp_ne_u32 vcc, s52, v8
    s_or_b64 s[64:65], s[64:65], vcc
    v_perm_b32 v8, v49, v48, s57
    v_perm_b32 v9, v51, v50, s58
    v_or_b32 v8, v8, v9
    v_cmp_ne_u32 vcc, s52, v8
    s_or_b64 s[64:65], s[64:65], vcc
    v_perm_b32 v8, v53, v52, s57
    v_perm_b32 v9, v55, v54, s58
    v_or_b32 v8, v8, v9
    v_cmp_ne_u32 vcc, s52, v8
    s_or_b64 s[64:65], s[64:65], vcc
    v_perm_b32 v8, v57, v56, s57
    v_perm_b32 v9, v59, v58, s58
    v_or_b32 v8, v8, v9
    v_cmp_ne_u32 vcc, s52, v8
    s_or_b64 s[64:65], s[64:65], vcc
    v_perm_b32 v8, v61, v60, s57
    v_perm_b32 v9, v63, v62, s58
    v_or_b32 v8, v8, v9
    v_cmp_ne_u32 vcc, s52, v8
    s_or_b64 s[64:65], s[64:65], vcc
    s_cmp_eq_u64 s[64:65], 0
    s_cbranch_scc0 L_x4_retry
L_x4_ok:
    v_add_f32 v32, v32, v36
    v_add_f32 v33, v33, v37
    v_add_f32 v34, v34, v38
    v_add_f32 v35, v35, v39
    v_add_f32 v32, v32, v40
    v_add_f32 v33, v33, v41
    v_add_f32 v34, v34, v42
    v_add_f32 v35, v35, v43
    v_add_f32 v32, v32, v44
    v_add_f32 v33, v33, v45
    v_add_f32 v34, v34, v46
    v_add_f32 v35, v35, v47
    v_add_f32 v32, v32, v48
    v_add_f32 v33, v33, v49
    v_add_f32 v34, v34, v50
    v_add_f32 v35, v35, v51
    v_add_f32 v32, v32, v52
    v_add_f32 v33, v33, v53
    v_add_f32 v34, v34, v54
    v_add_f32 v35, v35, v55
    v_add_f32 v32, v32, v56
    v_add_f32 v33, v33, v57
    v_add_f32 v34, v34, v58
    v_add_f32 v35, v35, v59
    v_add_f32 v32, v32, v60
    v_add_f32 v33, v33, v61
    v_add_f32 v34, v34, v62
    v_add_f32 v35, v35, v63
    v_cvt_pk_bf16_f32 v32, v32, v32
    v_cvt_pk_bf16_f32 v33, v33, v33
    v_cvt_pk_bf16_f32 v34, v34, v34
    v_cvt_pk_bf16_f32 v35, v35, v35
    v_mul_u32_u24 v8, 640, v6
    v_lshl_add_u32 v8, v7, 4, v8
    v_add_u32 v8, 155136, v8
    ds_write_b128 v8, v[32:35]
L5_n0:
    s_cmp_lg_u32 s3, 1
    s_cbranch_scc1 L5_n1
    s_mov_b32 s44, s24
    s_and_b32 s45, s25, 0xffff
    s_mov_b32 s46, 3072
    s_mov_b32 s47, 0x00020000
    v_cmp_gt_u32 vcc, 16, v1
    s_and_saveexec_b64 s[98:99], vcc
    v_lshrrev_b32 v6, 3, v1
    v_and_b32 v7, 7, v1
    v_mul_u32_u24 v2, 30720, v6
    v_lshl_add_u32 v2, v7, 4, v2
    s_lshl_b32 s64, s100, 7
    s_add_u32 s97, s64, 90112
    v_lshlrev_b32 v9, 3, v7
    s_lshl_b32 s64, s100, 6
    buffer_load_dwordx2 v[48:49], v9, s[44:47], s64 offen
    s_mov_b32 s70, 0
L_h_ld:
    s_mov_b32 s64, s97
    buffer_load_dwordx4 v[32:35], v2, s[36:39], s64 offen sc1
    s_add_u32 s64, s64, 61440
    buffer_load_dwordx4 v[36:39], v2, s[36:39], s64 offen sc1
    s_add_u32 s64, s64, 61440
    buffer_load_dwordx4 v[40:43], v2, s[36:39], s64 offen sc1
    s_add_u32 s64, s64, 61440
    buffer_load_dwordx4 v[44:47], v2, s[36:39], s64 offen sc1
    s_waitcnt vmcnt(0)
    s_mov_b64 s[64:65], 0
    v_perm_b32 v8, v33, v32, s57
    v_perm_b32 v9, v35, v34, s58
    v_or_b32 v8, v8, v9
    v_cmp_ne_u32 vcc, s52, v8
    s_or_b64 s[64:65], s[64:65], vcc
    v_perm_b32 v8, v37, v36, s57
    v_perm_b32 v9, v39, v38, s58
    v_or_b32 v8, v8, v9
    v_cmp_ne_u32 vcc, s52, v8
    s_or_b64 s[64:65], s[64:65], vcc
    v_perm_b32 v8, v41, v40, s57
    v_perm_b32 v9, v43, v42, s58
    v_or_b32 v8, v8, v9
    v_cmp_ne_u32 vcc, s52, v8
    s_or_b64 s[64:65], s[64:65], vcc
    v_perm_b32 v8, v45, v44, s57
    v_perm_b32 v9, v47, v46, s58
    v_or_b32 v8, v8, v9
    v_cmp_ne_u32 vcc, s52, v8
    s_or_b64 s[64:65], s[64:65], vcc
    s_cmp_eq_u64 s[64:65], 0
    s_cbranch_scc1 L_h_ok
    s_add_u32 s70, s70, 1
    s_cmp_lt_u32 s70, 524288
    s_cbranch_scc1 L_h_ld
L_h_ok:
    v_add_f32 v32, v32, v36
    v_add_f32 v40, v40, v44
    v_add_f32 v33, v33, v37
    v_add_f32 v41, v41, v45
    v_add_f32 v34, v34, v38
    v_add_f32 v42, v42, v46
    v_add_f32 v35, v35, v39
    v_add_f32 v43, v43, v47
    v_add_f32 v32, v32, v40
    v_add_f32 v33, v33, v41
    v_add_f32 v34, v34, v42
    v_add_f32 v35, v35, v43
    v_lshlrev_b32 v50, 16, v48
    v_and_b32 v51, 0xffff0000, v48
    v_lshlrev_b32 v52, 16, v49
    v_and_b32 v53, 0xffff0000, v49
    v_add_f32 v32, v32, v50
    v_max_f32 v32, 0, v32
    v_mul_f32 v32, v32, v32
    v_cvt_pk_bf16_f32 v32, v32, v32
    v_add_f32 v33, v33, v51
    v_max_f32 v33, 0, v33
    v_mul_f32 v33, v33, v33
    v_cvt_pk_bf16_f32 v33, v33, v33
    v_add_f32 v34, v34, v52
    v_max_f32 v34, 0, v34
    v_mul_f32 v34, v34, v34
    v_cvt_pk_bf16_f32 v34, v34, v34
    v_add_f32 v35, v35, v53
    v_max_f32 v35, 0, v35
    v_mul_f32 v35, v35, v35
    v_cvt_pk_bf16_f32 v35, v35, v35
    v_mul_u32_u24 v8, 640, v6
    v_lshl_add_u32 v8, v7, 4, v8
    v_add_u32 v8, 155648, v8
    ds_write_b128 v8, v[32:35]
    s_mov_b64 exec, s[98:99]
L5_n1:
    s_cmp_lg_u32 s3, 2
    s_cbranch_scc1 L_nofp
    s_cmp_ge_u32 s2, 40
    s_cbranch_scc1 L_nofp
    s_cmp_ge_u32 s2, 20
    s_cselect_b32 s66, 1, 0
    s_mul_i32 s67, s66, 20
    s_sub_u32 s67, s2, s67
    s_lshr_b32 s68, s67, 2
    s_and_b32 s69, s67, 3
    s_mov_b32 s40, s28
    s_and_b32 s41, s29, 0xffff
    s_mov_b32 s42, 1280
    s_mov_b32 s43, 0x00020000
    s_mov_b32 s44, s30
    s_and_b32 s45, s31, 0xffff
    s_mov_b32 s46, 2560
    s_mov_b32 s47, 0x00020000
    v_and_b32 v12, 7, v1
    v_lshrrev_b32 v13, 3, v1
    v_mul_u32_u24 v2, 6144, v13
    v_lshl_add_u32 v2, v12, 4, v2
    v_add_u32 v10, 4096, v2
    s_mul_i32 s64, s68, 49152
    s_lshl_b32 s65, s66, 9
    s_add_u32 s64, s64, s65
    s_lshl_b32 s65, s69, 7
    s_add_u32 s64, s64, s65
    s_add_u32 s32, s64, 917504
    s_lshl_b32 s71, s68, 8
    s_lshl_b32 s65, s69, 6
    s_add_u32 s71, s71, s65
    v_lshlrev_b32 v13, 3, v12
    buffer_load_dwordx2 v[24:25], v13, s[40:43], s71 offen
    s_mul_i32 s33, s66, 1280
    s_add_u32 s33, s33, s71
    buffer_load_dwordx2 v[14:15], v13, s[48:51], s33 offen
L_nofp:
    v_bfe_u32 v6, v1, 3, 1
    v_mul_u32_u24 v6, 640, v6
    v_lshl_add_u32 v6, v5, 2, v6
    v_add_u32 v6, 155136, v6
    s_lshl_b32 s64, s3, 6
    v_add_u32 v7, s64, v6
    s_lshl_b32 s64, s3, 4
    v_add_u32 v9, s64, v6
    v_lshlrev_b32 v3, 4, v0
    v_add_u32 v3, 129024, v3
    v_lshrrev_b32 v11, 5, v1
    v_lshlrev_b32 v11, 9, v11
    v_lshl_add_u32 v11, v4, 5, v11
    v_bfe_u32 v8, v1, 4, 1
    v_lshl_add_u32 v11, v8, 4, v11
    s_mul_i32 s72, s101, 48
    s_add_u32 s72, s72, s100
    s_lshl_b32 s72, s72, 10
    s_add_u32 s72, s72, 917504
    s_waitcnt vmcnt(0) lgkmcnt(0)
    s_barrier
    ds_read_b32 v16, v7 offset:0
    ds_read_b32 v17, v7 offset:16
    ds_read_b32 v18, v7 offset:32
    ds_read_b32 v19, v7 offset:48
    ds_read_b32 v20, v9 offset:512
    s_waitcnt lgkmcnt(4)
    v_and_b32 v208, v16, v28
    v_and_b32 v209, v16, v29
    v_and_b32 v210, v16, v30
    v_and_b32 v211, v16, v31
    s_waitcnt lgkmcnt(3)
    v_and_b32 v212, v17, v28
    v_and_b32 v213, v17, v29
    v_and_b32 v214, v17, v30
    v_and_b32 v215, v17, v31
    v_mfma_f32_16x16x32_bf16 v[56:59], v[208:211], v[88:91], 0
    s_waitcnt lgkmcnt(2)
    v_and_b32 v216, v18, v28
    v_and_b32 v217, v18, v29
    v_and_b32 v218, v18, v30
    v_and_b32 v219, v18, v31
    v_mfma_f32_16x16x32_bf16 v[56:59], v[212:215], v[92:95], v[56:59]
    s_waitcnt lgkmcnt(1)
    v_and_b32 v220, v19, v28
    v_and_b32 v221, v19, v29
    v_and_b32 v222, v19, v30
    v_and_b32 v223, v19, v31
    v_mfma_f32_16x16x32_bf16 v[56:59], v[216:219], v[96:99], v[56:59]
    s_waitcnt lgkmcnt(0)
    v_and_b32 v224, v20, v28
    v_and_b32 v225, v20, v29
    v_and_b32 v226, v20, v30
    v_and_b32 v227, v20, v31
    v_mfma_f32_16x16x32_bf16 v[56:59], v[220:223], v[100:103], v[56:59]
    s_nop 0
    v_mfma_f32_16x16x32_bf16 v[56:59], v[224:227], v[104:107], v[56:59]
    v_lshlrev_b32 v8, 4, v1
    v_add_u32 v8, 129024, v8
    s_nop 5
    ds_write_b128 v3, v[56:59]
    s_waitcnt lgkmcnt(0)
    s_barrier
    s_cmp_lg_u32 s3, 0
    s_cbranch_scc1 L_x5c
    ds_read_b128 v[32:35], v8 offset:0
    ds_read_b128 v[36:39], v8 offset:1024
    ds_read_b128 v[40:43], v8 offset:2048
    ds_read_b128 v[44:47], v8 offset:3072
    ds_read_b128 v[48:51], v8 offset:4096
    ds_read_b128 v[52:55], v8 offset:5120
    ds_read_b128 v[56:59], v8 offset:6144
    ds_read_b128 v[60:63], v8 offset:7168
    s_waitcnt lgkmcnt(6)
    v_add_f32 v32, v32, v36
    v_add_f32 v33, v33, v37
    v_add_f32 v34, v34, v38
    v_add_f32 v35, v35, v39
    s_waitcnt lgkmcnt(4)
    v_add_f32 v40, v40, v44
    v_add_f32 v41, v41, v45
    v_add_f32 v42, v42, v46
    v_add_f32 v43, v43, v47
    s_waitcnt lgkmcnt(2)
    v_add_f32 v48, v48, v52
    v_add_f32 v49, v49, v53
    v_add_f32 v50, v50, v54
    v_add_f32 v51, v51, v55
    s_waitcnt lgkmcnt(0)
    v_add_f32 v56, v56, v60
    v_add_f32 v57, v57, v61
    v_add_f32 v58, v58, v62
    v_add_f32 v59, v59, v63
    v_add_f32 v32, v32, v40
    v_add_f32 v48, v48, v56
    v_add_f32 v33, v33, v41
    v_add_f32 v49, v49, v57
    v_add_f32 v34, v34, v42
    v_add_f32 v50, v50, v58
    v_add_f32 v35, v35, v43
    v_add_f32 v51, v51, v59
    v_add_f32 v32, v32, v48
    v_add_f32 v33, v33, v49
    v_add_f32 v34, v34, v50
    v_add_f32 v35, v35, v51
    v_and_or_b32 v32, v32, v27, s53
    v_and_or_b32 v33, v33, v27, s54
    v_and_or_b32 v34, v34, v27, s55
    v_and_or_b32 v35, v35, v27, s56
    buffer_store_dwordx4 v[32:35], v11, s[36:39], s72 offen sc1
    s_branch L_fin
L_x5c:
    s_cmp_lg_u32 s3, 2
    s_cbranch_scc1 L_fin
    s_cmp_ge_u32 s2, 40
    s_cbranch_scc1 L_fin
    s_mov_b32 s70, 0
    buffer_load_dwordx4 v[32:35], v2, s[36:39], s32 offen offset:0 sc1
    buffer_load_dwordx4 v[36:39], v2, s[36:39], s32 offen offset:1024 sc1
    buffer_load_dwordx4 v[40:43], v2, s[36:39], s32 offen offset:2048 sc1
    buffer_load_dwordx4 v[44:47], v2, s[36:39], s32 offen offset:3072 sc1
    buffer_load_dwordx4 v[48:51], v10, s[36:39], s32 offen offset:0 sc1
    buffer_load_dwordx4 v[52:55], v10, s[36:39], s32 offen offset:1024 sc1
    s_mov_b64 s[72:73], -1
    s_mov_b64 s[74:75], -1
    s_mov_b64 s[76:77], -1
    s_mov_b64 s[78:79], -1
    s_mov_b64 s[80:81], -1
    s_mov_b64 s[82:83], -1
L_x5_chk:
    s_waitcnt vmcnt(0)
    s_mov_b64 s[66:67], 0
    s_cmp_eq_u64 s[72:73], 0
    s_cbranch_scc1 L_x5_c0
    v_perm_b32 v8, v33, v32, s57
    v_perm_b32 v9, v35, v34, s58
    v_or_b32 v8, v8, v9
    v_cmp_ne_u32 s[72:73], s52, v8
    s_or_b64 s[66:67], s[66:67], s[72:73]
L_x5_c0:
    s_cmp_eq_u64 s[74:75], 0
    s_cbranch_scc1 L_x5_c1
    v_perm_b32 v8, v37, v36, s57
    v_perm_b32 v9, v39, v38, s58
    v_or_b32 v8, v8, v9
    v_cmp_ne_u32 s[74:75], s52, v8
    s_or_b64 s[66:67], s[66:67], s[74:75]
L_x5_c1:
    s_cmp_eq_u64 s[76:77], 0
    s_cbranch_scc1 L_x5_c2
    v_perm_b32 v8, v41, v40, s57
    v_perm_b32 v9, v43, v42, s58
    v_or_b32 v8, v8, v9
    v_cmp_ne_u32 s[76:77], s52, v8
    s_or_b64 s[66:67], s[66:67], s[76:77]
L_x5_c2:
    s_cmp_eq_u64 s[78:79], 0
    s_cbranch_scc1 L_x5_c3
    v_perm_b32 v8, v45, v44, s57
    v_perm_b32 v9, v47, v46, s58
    v_or_b32 v8, v8, v9
    v_cmp_ne_u32 s[78:79], s52, v8
    s_or_b64 s[66:67], s[66:67], s[78:79]
L_x5_c3:
    s_cmp_eq_u64 s[80:81], 0
    s_cbranch_scc1 L_x5_c4
    v_perm_b32 v8, v49, v48, s57
    v_perm_b32 v9, v51, v50, s58
    v_or_b32 v8, v8, v9
    v_cmp_ne_u32 s[80:81], s52, v8
    s_or_b64 s[66:67], s[66:67], s[80:81]
L_x5_c4:
    s_cmp_eq_u64 s[82:83], 0
    s_cbranch_scc1 L_x5_c5
    v_perm_b32 v8, v53, v52, s57
    v_perm_b32 v9, v55, v54, s58
    v_or_b32 v8, v8, v9
    v_cmp_ne_u32 s[82:83], s52, v8
    s_or_b64 s[66:67], s[66:67], s[82:83]
L_x5_c5:
    s_cmp_eq_u64 s[66:67], 0
    s_cbranch_scc1 L_x5_ok
    s_add_u32 s70, s70, 1
    s_cmp_ge_u32 s70, 524288
    s_cbranch_scc1 L_x5_ok
    s_cmp_eq_u64 s[72:73], 0
    s_cbranch_scc1 L_x5_r0
    buffer_load_dwordx4 v[32:35], v2, s[36:39], s32 offen offset:0 sc1
L_x5_r0:
    s_cmp_eq_u64 s[74:75], 0
    s_cbranch_scc1 L_x5_r1
    buffer_load_dwordx4 v[36:39], v2, s[36:39], s32 offen offset:1024 sc1
L_x5_r1:
    s_cmp_eq_u64 s[76:77], 0
    s_cbranch_scc1 L_x5_r2
    buffer_load_dwordx4 v[40:43], v2, s[36:39], s32 offen offset:2048 sc1
L_x5_r2:
    s_cmp_eq_u64 s[78:79], 0
    s_cbranch_scc1 L_x5_r3
    buffer_load_dwordx4 v[44:47], v2, s[36:39], s32 offen offset:3072 sc1
L_x5_r3:
    s_cmp_eq_u64 s[80:81], 0
    s_cbranch_scc1 L_x5_r4
    buffer_load_dwordx4 v[48:51], v10, s[36:39], s32 offen offset:0 sc1
L_x5_r4:
    s_cmp_eq_u64 s[82:83], 0
    s_cbranch_scc1 L_x5_r5
    buffer_load_dwordx4 v[52:55], v10, s[36:39], s32 offen offset:1024 sc1
L_x5_r5:
    s_branch L_x5_chk
L_x5_ok:
    v_add_f32 v32, v32, v36
    v_add_f32 v40, v40, v44
    v_add_f32 v48, v48, v52
    v_add_f32 v33, v33, v37
    v_add_f32 v41, v41, v45
    v_add_f32 v49, v49, v53
    v_add_f32 v34, v34, v38
    v_add_f32 v42, v42, v46
    v_add_f32 v50, v50, v54
    v_add_f32 v35, v35, v39
    v_add_f32 v43, v43, v47
    v_add_f32 v51, v51, v55
    v_add_f32 v32, v32, v40
    v_add_f32 v33, v33, v41
    v_add_f32 v34, v34, v42
    v_add_f32 v35, v35, v43
    v_lshlrev_b32 v40, 16, v24
    v_and_b32 v41, 0xffff0000, v24
    v_lshlrev_b32 v42, 16, v25
    v_and_b32 v43, 0xffff0000, v25
    v_add_f32 v32, v32, v48
    v_add_f32 v33, v33, v49
    v_add_f32 v34, v34, v50
    v_add_f32 v35, v35, v51
    v_lshlrev_b32 v44, 16, v14
    v_and_b32 v45, 0xffff0000, v14
    v_lshlrev_b32 v46, 16, v15
    v_and_b32 v47, 0xffff0000, v15
    v_add_f32_dpp v32, v32, v32 row_ror:8 row_mask:0xf bank_mask:0xf
    v_add_f32_dpp v33, v33, v33 row_ror:8 row_mask:0xf bank_mask:0xf
    v_add_f32_dpp v34, v34, v34 row_ror:8 row_mask:0xf bank_mask:0xf
    v_add_f32_dpp v35, v35, v35 row_ror:8 row_mask:0xf bank_mask:0xf
    v_add_f32 v40, v40, v44
    v_add_f32 v41, v41, v45
    v_add_f32 v42, v42, v46
    v_add_f32 v43, v43, v47
    v_mov_b32 v48, v32
    v_mov_b32 v49, v33
    v_mov_b32 v50, v34
    v_mov_b32 v51, v35
    s_nop 1
    v_permlane16_swap_b32 v32, v48
    v_permlane16_swap_b32 v33, v49
    v_permlane16_swap_b32 v34, v50
    v_permlane16_swap_b32 v35, v51
    s_nop 1
    v_add_f32 v32, v32, v48
    v_add_f32 v33, v33, v49
    v_add_f32 v34, v34, v50
    v_add_f32 v35, v35, v51
    v_mov_b32 v48, v32
    v_mov_b32 v49, v33
    v_mov_b32 v50, v34
    v_mov_b32 v51, v35
    s_nop 1
    v_permlane32_swap_b32 v32, v48
    v_permlane32_swap_b32 v33, v49
    v_permlane32_swap_b32 v34, v50
    v_permlane32_swap_b32 v35, v51
    s_nop 1
    v_add_f32 v32, v32, v48
    v_add_f32 v33, v33, v49
    v_add_f32 v34, v34, v50
    v_add_f32 v35, v35, v51
    v_add_f32 v32, v32, v40
    v_add_f32 v33, v33, v41
    v_add_f32 v34, v34, v42
    v_add_f32 v35, v35, v43
    v_cvt_pk_bf16_f32 v32, v32, v33
    v_cvt_pk_bf16_f32 v33, v34, v35
    s_mov_b64 exec, 0xff
    buffer_store_dwordx2 v[32:33], v13, s[44:47], s33 offen
    s_mov_b64 exec, -1
    s_cmp_lg_u32 s2, 0
    s_cbranch_scc1 L_fin
    s_mov_b32 s64, 0
    v_mov_b32 v6, s52
    v_mov_b32 v7, 0
    s_mov_b64 s[98:99], exec
    s_mov_b64 exec, 1
    buffer_store_dword v6, v7, s[36:39], s64 offen sc1
    s_mov_b64 exec, s[98:99]
L_fin:
    s_waitcnt vmcnt(0)
L_end:
    s_endpgm
L_x1_retry:
    s_add_u32 s70, s70, 1
    s_cmp_ge_u32 s70, 524288
    s_cbranch_scc1 L_x1_ok
    s_add_u32 s64, s33, 0
    buffer_load_dwordx4 v[32:35], v3, s[36:39], s64 offen sc1
    s_add_u32 s64, s64, 61440
    buffer_load_dwordx4 v[36:39], v3, s[36:39], s64 offen sc1
    s_add_u32 s64, s64, 61440
    buffer_load_dwordx4 v[40:43], v3, s[36:39], s64 offen sc1
    s_add_u32 s64, s64, 61440
    buffer_load_dwordx4 v[44:47], v3, s[36:39], s64 offen sc1
    s_add_u32 s64, s33, 30720
    buffer_load_dwordx4 v[48:51], v3, s[36:39], s64 offen sc1
    s_add_u32 s64, s64, 61440
    buffer_load_dwordx4 v[52:55], v3, s[36:39], s64 offen sc1
    s_add_u32 s64, s64, 61440
    buffer_load_dwordx4 v[56:59], v3, s[36:39], s64 offen sc1
    s_add_u32 s64, s64, 61440
    buffer_load_dwordx4 v[60:63], v3, s[36:39], s64 offen sc1
    s_branch L_x1_chk
L_q_retry:
    s_add_u32 s70, s70, 1
    s_cmp_ge_u32 s70, 524288
    s_cbranch_scc1 L_q_ok
    s_cmp_eq_u64 s[72:73], 0
    s_cbranch_scc1 L_q_r0
    buffer_load_dwordx4 v[32:35], v2, s[36:39], s32 offen offset:0 sc1
L_q_r0:
    s_cmp_eq_u64 s[74:75], 0
    s_cbranch_scc1 L_q_r1
    buffer_load_dwordx4 v[36:39], v2, s[36:39], s32 offen offset:1024 sc1
L_q_r1:
    s_cmp_eq_u64 s[76:77], 0
    s_cbranch_scc1 L_q_r2
    buffer_load_dwordx4 v[40:43], v2, s[36:39], s32 offen offset:2048 sc1
L_q_r2:
    s_cmp_eq_u64 s[78:79], 0
    s_cbranch_scc1 L_q_r3
    buffer_load_dwordx4 v[44:47], v2, s[36:39], s32 offen offset:3072 sc1
L_q_r3:
    s_cmp_eq_u64 s[80:81], 0
    s_cbranch_scc1 L_q_r4
    buffer_load_dwordx4 v[48:51], v3, s[36:39], s32 offen offset:0 sc1
L_q_r4:
    s_cmp_eq_u64 s[82:83], 0
    s_cbranch_scc1 L_q_r5
    buffer_load_dwordx4 v[52:55], v3, s[36:39], s32 offen offset:1024 sc1
L_q_r5:
    s_cmp_eq_u64 s[84:85], 0
    s_cbranch_scc1 L_q_r6
    buffer_load_dwordx4 v[56:59], v3, s[36:39], s32 offen offset:2048 sc1
L_q_r6:
    s_cmp_eq_u64 s[86:87], 0
    s_cbranch_scc1 L_q_r7
    buffer_load_dwordx4 v[60:63], v3, s[36:39], s32 offen offset:3072 sc1
L_q_r7:
    s_waitcnt vmcnt(0)
    s_branch L_q_chk
L_x3_retry:
    s_add_u32 s70, s70, 1
    s_cmp_ge_u32 s70, 524288
    s_cbranch_scc1 L_x3_ok
    s_mov_b64 exec, 0xffff
    buffer_load_dwordx4 v[8:11], v2, s[36:39], s33 offen sc1
    s_mov_b64 exec, -1
    buffer_load_dwordx4 v[32:35], v3, s[36:39], s32 offen offset:0 sc1
    buffer_load_dwordx4 v[36:39], v3, s[36:39], s32 offen offset:1024 sc1
    buffer_load_dwordx4 v[40:43], v3, s[36:39], s32 offen offset:2048 sc1
    buffer_load_dwordx4 v[44:47], v3, s[36:39], s32 offen offset:3072 sc1
    s_waitcnt vmcnt(0)
    s_branch L_x3_chk
L_x4_retry:
    s_add_u32 s70, s70, 1
    s_cmp_lt_u32 s70, 524288
    s_cbranch_scc1 L_x4_ld
    s_branch L_x4_ok
L_codeend:
.section .rodata,"a"
.p2align 6
.amdhsa_kernel parallel_sum__compressed_kv_cla__dense_activation_squared_relu__decode_kernel
  .amdhsa_next_free_vgpr 256
  .amdhsa_next_free_sgpr 102
  .amdhsa_accum_offset 256
  .amdhsa_group_segment_fixed_size 0
  .amdhsa_kernarg_size 112
  .amdhsa_user_sgpr_count 2
  .amdhsa_user_sgpr_kernarg_segment_ptr 1
  .amdhsa_system_sgpr_workgroup_id_x 1
  .amdhsa_float_denorm_mode_32 3
.end_amdhsa_kernel
.text
```
